```python
import torch

def _softmax(x, axis=-1):
    return torch.softmax(x, dim=axis)
def _gelu(x):
    return torch.nn.functional.gelu(x, approximate="tanh")
def _silu(x):
    return torch.nn.functional.silu(x)
def _sigmoid(x):
    return torch.sigmoid(x)
def _layernorm(x, axis=-1, eps=1e-5):
    m = x.mean(dim=axis, keepdim=True)
    v = x.var(dim=axis, keepdim=True, unbiased=False)
    return (x - m) / torch.sqrt(v + eps)
def _scatter_add(tgt, idx, src, axis=0):
    return tgt.clone().index_add_(axis, idx, src)
def _segment_sum(src, seg, n):
    out = torch.zeros((n,) + src.shape[1:], dtype=src.dtype)
    return out.index_add_(0, seg, src)
def _pad(x, pw):
    flat = tuple(v for pair in reversed(pw) for v in pair)
    return torch.nn.functional.pad(x, flat)

kernel_name = 'parallel_sum__mha_block__geglu_ffn__prompt'

def setup_inputs():

    _w = (lambda a: (lambda t: t.to(torch.bfloat16) if t.is_floating_point() else t)(torch.as_tensor(a)))
    def _A_setup():
        B, S, D, H = 1, 2048, 512, 32
        return {
            "x": _w((lambda *s: torch.randn(*s, dtype=torch.bfloat16) * 0.05)(B, S, D)),
            "wqkv": _w((lambda *s: torch.randn(*s, dtype=torch.bfloat16) * 0.2)(D, 3 * D)),
            "wo": _w((lambda *s: torch.randn(*s, dtype=torch.bfloat16) * 0.1)(D, D)),
        }
    _A_in = _A_setup()

    def _B_setup():
        B, S, D, F = 1, 2048, 512, 1792
        return {
            "x": _w((lambda *s: torch.randn(*s, dtype=torch.bfloat16) * 0.05)(B, S, D)),
            "w_gate": _w((lambda *s: torch.randn(*s, dtype=torch.bfloat16) * 0.1)(D, F)),
            "w_up": _w((lambda *s: torch.randn(*s, dtype=torch.bfloat16) * 0.1)(D, F)),
            "w_down": _w((lambda *s: torch.randn(*s, dtype=torch.bfloat16) * 0.1)(F, D)),
        }
    _B_in = _B_setup()

    return {
        "A_x": _A_in["x"],
        "A_wqkv": _A_in["wqkv"],
        "A_wo": _A_in["wo"],
        "B_x": _B_in["x"],
        "B_w_gate": _B_in["w_gate"],
        "B_w_up": _B_in["w_up"],
        "B_w_down": _B_in["w_down"],
    }

def reference(A_x, A_wqkv, A_wo, B_x, B_w_gate, B_w_up, B_w_down):
    def _A_ref(x, wqkv, wo):
        B, S, D = x.shape
        H = 32
        Dh = D // H
        qkv = (lambda x, *d: x.permute(*d))((x @ wqkv).reshape(B, S, 3, H, Dh), 2, 0, 3, 1, 4)
        q, k, v = qkv[0], qkv[1], qkv[2]
        scores = torch.einsum("bhqd,bhkd->bhqk", q, k) * (Dh ** -0.5)
        p = _softmax(scores, axis=-1)
        o = torch.einsum("bhqk,bhkd->bhqd", p, v)
        return (lambda x, *d: x.permute(*d))(o, 0, 2, 1, 3).reshape(B, S, D) @ wo

    def _B_ref(x, w_gate, w_up, w_down):
        return (_gelu(x @ w_gate) * (x @ w_up)) @ w_down

    x = A_x
    xn = _layernorm(x, axis=-1)
    return x + _A_ref(xn, A_wqkv, A_wo) + _B_ref(xn, B_w_gate, B_w_up, B_w_down)
```

```asm
; @launch grid=(256,1,1) block=(256,1,1) lds=163840
.amdgcn_target "amdgcn-amd-amdhsa--gfx950"
.text
.globl parallel_sum__mha_block__geglu_ffn__prompt_kernel
.p2align 8
.type parallel_sum__mha_block__geglu_ffn__prompt_kernel,@function
parallel_sum__mha_block__geglu_ffn__prompt_kernel:
  s_cmp_ge_u32 s2, 256
  s_cbranch_scc1 L_exit
  s_load_dwordx16 s[36:51], s[0:1], 0
  s_load_dwordx4 s[52:55], s[0:1], 64
  s_getpc_b64 s[84:85]
L_pc0:
  v_lshlrev_b32 v24, 7, v0
  v_min_u32 v24, L_exit-L_pc0, v24
  global_load_dword v255, v24, s[84:85]
  v_lshrrev_b32 v2, 6, v0
  v_and_b32 v1, 63, v0
  s_and_b32 s61, s2, 7
  s_lshr_b32 s62, s2, 3
  v_readfirstlane_b32 s56, v2
  s_lshr_b32 s72, s61, 2
  s_lshl_b32 s72, s72, 3
  s_and_b32 s73, s62, 7
  s_add_u32 s59, s72, s73
  s_and_b32 s72, s61, 3
  s_lshl_b32 s72, s72, 2
  s_lshr_b32 s73, s62, 3
  s_lshl_b32 s73, s73, 2
  s_lshr_b32 s73, 0x3021, s73
  s_and_b32 s73, s73, 15
  s_add_u32 s60, s72, s73
  s_and_b32 s90, s60, 3
  v_lshrrev_b32 v26, 3, v1
  v_and_b32 v27, 7, v1
  v_lshrrev_b32 v28, 4, v1
  v_xor_b32 v27, v27, v28
  v_lshlrev_b32 v26, 10, v26
  v_lshl_add_u32 v2, v27, 4, v26
  v_xor_b32 v3, 64, v2
  v_add_u32 v3, 0x2000, v3
  s_lshl_b32 s72, s59, 17
  s_lshl_b32 s73, s56, 15
  s_add_u32 s63, s72, s73
  s_lshl_b32 s64, s56, 13
  s_waitcnt lgkmcnt(0)
  s_mov_b32 s4, s36
  s_mov_b32 s5, s37
  s_mov_b32 s6, 0x00200000
  s_mov_b32 s7, 0x20000
  s_add_u32 s93, s90, 0
  s_and_b32 s93, s93, 3
  s_lshl_b32 s94, s93, 15
  s_add_u32 s94, s94, s64
  s_lshl_b32 s93, s93, 8
  s_add_u32 s93, s93, s63
  s_add_u32 s92, s93, 0
  s_add_u32 m0, s94, 0
  s_nop 0
  buffer_load_dwordx4 v2, s[4:7], s92 offen lds
  s_add_u32 s92, s93, 0
  s_add_u32 m0, s94, 1024
  s_nop 0
  buffer_load_dwordx4 v3, s[4:7], s92 offen lds
  s_add_u32 s92, s93, 16384
  s_add_u32 m0, s94, 2048
  s_nop 0
  buffer_load_dwordx4 v2, s[4:7], s92 offen lds
  s_add_u32 s92, s93, 16384
  s_add_u32 m0, s94, 3072
  s_nop 0
  buffer_load_dwordx4 v3, s[4:7], s92 offen lds
  s_add_u32 s92, s93, 128
  s_add_u32 m0, s94, 4096
  s_nop 0
  buffer_load_dwordx4 v2, s[4:7], s92 offen lds
  s_add_u32 s92, s93, 128
  s_add_u32 m0, s94, 5120
  s_nop 0
  buffer_load_dwordx4 v3, s[4:7], s92 offen lds
  s_add_u32 s92, s93, 16512
  s_add_u32 m0, s94, 6144
  s_nop 0
  buffer_load_dwordx4 v2, s[4:7], s92 offen lds
  s_add_u32 s92, s93, 16512
  s_add_u32 m0, s94, 7168
  s_nop 0
  buffer_load_dwordx4 v3, s[4:7], s92 offen lds
  s_add_u32 s93, s90, 1
  s_and_b32 s93, s93, 3
  s_lshl_b32 s94, s93, 15
  s_add_u32 s94, s94, s64
  s_lshl_b32 s93, s93, 8
  s_add_u32 s93, s93, s63
  s_add_u32 s92, s93, 0
  s_add_u32 m0, s94, 0
  s_cmp_eq_u32 s56, 2
  s_cselect_b32 s72, s44, s46
  s_cselect_b32 s73, s45, s47
  s_mov_b32 s89, 12288
  s_cselect_b32 s66, s89, 18560
  buffer_load_dwordx4 v2, s[4:7], s92 offen lds
  s_cmp_lt_u32 s56, 2
  s_cselect_b32 s8, s38, s72
  s_cselect_b32 s9, s39, s73
  s_mov_b32 s89, 1572864
  s_cselect_b32 s10, s89, 1835008
  s_mov_b32 s11, 0x20000
  s_mul_i32 s74, s56, 6144
  s_cselect_b32 s66, s74, s66
  s_cselect_b32 s84, 11, 10
  s_cselect_b32 s85, 12, 6
  s_mov_b32 s89, 3072
  s_cselect_b32 s86, s89, 3584
  s_mov_b32 s89, 49152
  s_cselect_b32 s57, s89, 114688
  s_mul_i32 s75, s56, 98304
  s_cselect_b32 s75, s75, 0
  s_mul_i32 s88, s60, 96
  s_add_u32 s88, s88, 2048
  s_and_b32 s74, s60, 1
  s_lshl_b32 s74, s74, 10
  s_add_u32 s92, s93, 0
  s_add_u32 m0, s94, 1024
  s_lshr_b32 s87, s60, 1
  buffer_load_dwordx4 v3, s[4:7], s92 offen lds
  s_lshl_b32 s87, s87, 7
  s_add_u32 s74, s74, s87
  s_lshl_b32 s87, s60, 6
  s_add_u32 s87, s87, 2048
  s_sub_u32 s87, s87, s74
  s_add_u32 s92, s93, 16384
  s_add_u32 m0, s94, 2048
  s_cmp_lt_u32 s56, 2
  s_cselect_b32 s74, s74, s88
  buffer_load_dwordx4 v2, s[4:7], s92 offen lds
  s_add_u32 s65, s75, s74
  s_lshl_b32 s67, s86, 6
  v_add_u32 v26, 0, v1
  v_mul_u32_u24 v27, 171, v26
  v_lshrrev_b32 v27, s84, v27
  s_add_u32 s92, s93, 16384
  s_add_u32 m0, s94, 3072
  v_mul_u32_u24 v28, s85, v27
  buffer_load_dwordx4 v3, s[4:7], s92 offen lds
  v_sub_u32 v28, v26, v28
  v_mul_u32_u24 v27, s86, v27
  v_lshrrev_b32 v29, 3, v28
  v_mul_u32_u24 v29, s87, v29
  v_and_b32 v28, 7, v28
  s_add_u32 s92, s93, 128
  s_add_u32 m0, s94, 4096
  v_lshlrev_b32 v28, 4, v28
  buffer_load_dwordx4 v2, s[4:7], s92 offen lds
  v_add3_u32 v8, v27, v28, v29
  v_add_u32 v26, 64, v1
  v_mul_u32_u24 v27, 171, v26
  v_lshrrev_b32 v27, s84, v27
  v_mul_u32_u24 v28, s85, v27
  s_add_u32 s92, s93, 128
  s_add_u32 m0, s94, 5120
  v_sub_u32 v28, v26, v28
  buffer_load_dwordx4 v3, s[4:7], s92 offen lds
  v_mul_u32_u24 v27, s86, v27
  v_lshrrev_b32 v29, 3, v28
  v_mul_u32_u24 v29, s87, v29
  v_and_b32 v28, 7, v28
  v_lshlrev_b32 v28, 4, v28
  s_add_u32 s92, s93, 16512
  s_add_u32 m0, s94, 6144
  v_add3_u32 v9, v27, v28, v29
  buffer_load_dwordx4 v2, s[4:7], s92 offen lds
  v_subrev_u32 v9, 1024, v9
  v_add_u32 v26, 128, v1
  v_mul_u32_u24 v27, 171, v26
  v_lshrrev_b32 v27, s84, v27
  v_mul_u32_u24 v28, s85, v27
  s_add_u32 s92, s93, 16512
  s_add_u32 m0, s94, 7168
  v_sub_u32 v28, v26, v28
  buffer_load_dwordx4 v3, s[4:7], s92 offen lds
  v_mul_u32_u24 v27, s86, v27
  v_lshrrev_b32 v29, 3, v28
  v_mul_u32_u24 v29, s87, v29
  v_and_b32 v28, 7, v28
  v_lshlrev_b32 v28, 4, v28
  s_add_u32 s93, s90, 2
  s_and_b32 s93, s93, 3
  s_lshl_b32 s94, s93, 15
  s_add_u32 s94, s94, s64
  s_lshl_b32 s93, s93, 8
  s_add_u32 s93, s93, s63
  s_add_u32 s92, s93, 0
  s_add_u32 m0, s94, 0
  v_add3_u32 v10, v27, v28, v29
  buffer_load_dwordx4 v2, s[4:7], s92 offen lds
  v_subrev_u32 v10, 2048, v10
  s_cmp_lt_u32 s56, 2
  s_cselect_b32 s12, s44, s46
  s_cselect_b32 s13, s45, s47
  s_mov_b32 s14, 1835008
  s_mov_b32 s15, 0x20000
  s_and_b32 s75, s56, 1
  s_add_u32 s92, s93, 0
  s_add_u32 m0, s94, 1024
  s_mul_i32 s72, s75, 229376
  buffer_load_dwordx4 v3, s[4:7], s92 offen lds
  s_lshl_b32 s73, s60, 7
  s_add_u32 s68, s72, s73
  s_lshl_b32 s69, s56, 13
  s_lshr_b32 s72, s56, 1
  s_lshl_b32 s72, s72, 2
  s_add_u32 s92, s93, 16384
  s_add_u32 m0, s94, 2048
  v_lshrrev_b32 v26, 3, v1
  buffer_load_dwordx4 v2, s[4:7], s92 offen lds
  v_and_b32 v27, 7, v1
  v_and_b32 v28, 2, v26
  v_xor_b32 v27, v27, v28
  v_xor_b32 v27, s72, v27
  v_mul_u32_u24 v26, 3584, v26
  s_add_u32 s92, s93, 16384
  s_add_u32 m0, s94, 3072
  v_lshl_add_u32 v11, v27, 4, v26
  buffer_load_dwordx4 v3, s[4:7], s92 offen lds
  v_and_b32 v26, 31, v1
  v_lshrrev_b32 v27, 5, v1
  v_bfe_u32 v28, v26, 1, 3
  v_xor_b32 v27, v27, v28
  v_lshlrev_b32 v26, 7, v26
  s_add_u32 s92, s93, 128
  s_add_u32 m0, s94, 4096
  v_lshl_add_u32 v26, v27, 4, v26
  buffer_load_dwordx4 v2, s[4:7], s92 offen lds
  v_add_u32 v4, s64, v26
  v_xor_b32 v5, 32, v4
  v_xor_b32 v6, 64, v4
  v_xor_b32 v7, 0x60, v4
  v_mov_b32 v20, 0xffff0000
  s_add_u32 s92, s93, 128
  s_add_u32 m0, s94, 5120
  v_lshlrev_b32 v21, 4, v1
  buffer_load_dwordx4 v3, s[4:7], s92 offen lds
  v_mov_b32 v23, 0xc0135761
  s_mov_b32 s70, 0xbdd2d3e8
  s_mov_b32 s71, 0x3eb8aa3b
  s_mov_b32 s79, 0x3f803f80
  s_mov_b32 s16, s54
  s_add_u32 s92, s93, 16512
  s_add_u32 m0, s94, 6144
  s_mov_b32 s17, s55
  buffer_load_dwordx4 v2, s[4:7], s92 offen lds
  s_mov_b32 s18, 0x01100000
  s_mov_b32 s19, 0x20000
  s_mov_b32 s20, s48
  s_mov_b32 s21, s49
  s_mov_b32 s22, 0x001c0000
  s_add_u32 s92, s93, 16512
  s_add_u32 m0, s94, 7168
  s_mov_b32 s23, 0x20000
  buffer_load_dwordx4 v3, s[4:7], s92 offen lds
  s_mov_b32 s24, s40
  s_mov_b32 s25, s41
  s_mov_b32 s26, 0x00080000
  s_mov_b32 s27, 0x20000
  s_mov_b32 s32, s52
  s_add_u32 s93, s90, 3
  s_and_b32 s93, s93, 3
  s_lshl_b32 s94, s93, 15
  s_add_u32 s94, s94, s64
  s_lshl_b32 s93, s93, 8
  s_add_u32 s93, s93, s63
  s_add_u32 s92, s93, 0
  s_add_u32 m0, s94, 0
  s_mov_b32 s33, s53
  buffer_load_dwordx4 v2, s[4:7], s92 offen lds
  s_mov_b32 s34, 0x00000100
  s_mov_b32 s35, 0x20000
  s_lshl_b32 s72, s59, 2
  s_add_u32 s72, s72, s56
  s_lshl_b32 s73, s72, 10
  s_add_u32 s92, s93, 0
  s_add_u32 m0, s94, 1024
  s_lshr_b32 s74, s60, 1
  buffer_load_dwordx4 v3, s[4:7], s92 offen lds
  s_lshl_b32 s74, s74, 18
  s_add_u32 s76, s73, s74
  s_and_b32 s74, s60, 1
  s_mul_i32 s74, s74, 2097152
  s_add_u32 s76, s76, s74
  s_add_u32 s92, s93, 16384
  s_add_u32 m0, s94, 2048
  s_bitcmp1_b32 s60, 0
  s_cselect_b32 s71, 1.0, s71
  buffer_load_dwordx4 v2, s[4:7], s92 offen lds
  s_mul_i32 s73, s72, 1152
  s_mul_i32 s74, s60, 147456
  s_add_u32 s77, s73, s74
  s_mul_i32 s73, s72, 114688
  s_add_u32 s73, s73, 7340032
  s_add_u32 s92, s93, 16384
  s_add_u32 m0, s94, 3072
  s_mul_i32 s74, s60, 3072
  buffer_load_dwordx4 v3, s[4:7], s92 offen lds
  s_add_u32 s78, s73, s74
  s_add_u32 s78, s78, 65536
  s_lshl_b32 s74, s60, 12
  s_add_u32 s3, s73, s74
  s_mov_b32 s84, 73728
  s_add_u32 s92, s93, 128
  s_add_u32 m0, s94, 4096
  v_and_b32 v26, 15, v1
  buffer_load_dwordx4 v2, s[4:7], s92 offen lds
  v_lshlrev_b32 v26, 4, v26
  v_lshrrev_b32 v27, 5, v1
  v_mul_u32_u24 v27, 288, v27
  v_bfe_u32 v28, v1, 4, 1
  v_mul_lo_u32 v28, s84, v28
  s_add_u32 s92, s93, 128
  s_add_u32 m0, s94, 5120
  v_add3_u32 v22, v26, v27, v28
  buffer_load_dwordx4 v3, s[4:7], s92 offen lds
  s_and_b32 s72, s62, 3
  s_lshl_b32 s73, s61, 2
  s_add_u32 s80, s73, s72
  s_mov_b32 s82, s80
  s_lshr_b32 s81, s62, 2
  s_add_u32 s92, s93, 16512
  s_add_u32 m0, s94, 6144
  s_mov_b32 s83, s81
  buffer_load_dwordx4 v2, s[4:7], s92 offen lds
  s_lshr_b32 s72, s80, 1
  s_lshl_b32 s72, s72, 8
  s_add_u32 s58, s72, 16781312
  s_lshr_b32 s72, s80, 2
  s_lshl_b32 s72, s72, 8
  s_add_u32 s92, s93, 16512
  s_add_u32 m0, s94, 7168
  s_add_u32 s91, s72, 16777216
  buffer_load_dwordx4 v3, s[4:7], s92 offen lds
  v_and_b32 v24, 15, v1
  v_lshrrev_b32 v25, 2, v24
  v_lshrrev_b32 v26, 5, v1
  v_lshl_add_u32 v25, v26, 3, v25
  v_and_b32 v26, 3, v24
  s_mul_i32 s93, s67, 0
  s_add_u32 s93, s93, s65
  s_add_u32 m0, s66, 131072
  v_bfe_u32 v27, v1, 4, 1
  buffer_load_dwordx4 v8, s[8:11], s93 offen offset:0 lds
  v_mul_u32_u24 v28, 192, v25
  v_lshl_add_u32 v28, v26, 3, v28
  v_lshl_add_u32 v28, v27, 5, v28
  v_add_u32 v12, 131072, v28
  v_mul_u32_u24 v28, 96, v25
  v_lshl_add_u32 v28, v26, 3, v28
  buffer_load_dwordx4 v9, s[8:11], s93 offen offset:1024 lds
  v_mul_u32_u24 v29, 6272, v27
  v_add_u32 v28, v28, v29
  v_add_u32 v13, 143360, v28
  v_lshrrev_b32 v28, 1, v26
  v_lshrrev_b32 v29, 3, v24
  v_lshl_add_u32 v28, v29, 1, v28
  buffer_load_dwordx4 v10, s[8:11], s93 offen offset:2048 lds
  v_lshl_add_u32 v28, v27, 2, v28
  v_lshlrev_b32 v28, 4, v28
  v_lshl_add_u32 v28, v25, 7, v28
  v_lshl_add_u32 v28, v27, 14, v28
  v_and_b32 v29, 1, v24
  s_add_u32 s93, s93, s57
  s_add_u32 m0, s66, 134144
  v_lshl_add_u32 v28, v29, 3, v28
  buffer_load_dwordx4 v8, s[8:11], s93 offen offset:0 lds
  v_add_u32 v14, 98304, v28
  v_xor_b32 v15, 32, v14
  v_xor_b32 v16, 64, v14
  v_xor_b32 v17, 0x60, v14
  v_lshlrev_b32 v0, 7, v1
  s_cmp_lt_u32 s56, 2
  s_mov_b32 s88, 768
  s_cselect_b32 s88, s88, 896
  s_cselect_b32 s101, 0x7, 0x7f
  s_cselect_b32 s89, 384, 0
  buffer_load_dwordx4 v9, s[8:11], s93 offen offset:1024 lds
  s_mul_i32 s100, s2, s88
  s_and_b32 s88, s56, 1
  s_mul_i32 s88, s88, s89
  s_add_u32 s100, s100, s88
  buffer_load_dwordx4 v10, s[8:11], s93 offen offset:2048 lds
  s_mul_i32 s92, s67, 1
  s_add_u32 s92, s92, s100
  s_mov_b32 exec_lo, s101
  s_mov_b32 exec_hi, 0
  buffer_load_dword a1, v0, s[8:11], s92 offen
  s_mov_b64 exec, -1
  s_mul_i32 s92, s67, 2
  s_add_u32 s92, s92, s100
  s_mov_b32 exec_lo, s101
  s_mov_b32 exec_hi, 0
  buffer_load_dword a2, v0, s[8:11], s92 offen
  s_mov_b64 exec, -1
  s_mul_i32 s92, s67, 3
  s_add_u32 s92, s92, s100
  s_mov_b32 exec_lo, s101
  s_mov_b32 exec_hi, 0
  buffer_load_dword a3, v0, s[8:11], s92 offen
  s_mov_b64 exec, -1
  s_mul_i32 s92, s67, 4
  s_add_u32 s92, s92, s100
  s_mov_b32 exec_lo, s101
  s_mov_b32 exec_hi, 0
  buffer_load_dword a4, v0, s[8:11], s92 offen
  s_mov_b64 exec, -1
  s_mov_b32 s28, s50
  s_mov_b32 s29, s51
  s_mov_b32 s30, 0x00200000
  s_mov_b32 s31, 0x20000
  v_lshlrev_b32 v24, 21, v1
  v_lshlrev_b32 v25, 20, v1
  s_mov_b64 exec, 0x1ff
  buffer_load_dword a8, v24, s[16:19], 0 offen
  s_mov_b64 exec, 3
  buffer_load_dword a9, v25, s[28:31], 0 offen
  s_mov_b64 exec, -1
  s_cmp_lg_u32 s2, 0
  s_cbranch_scc1 L_init_1
  s_cmp_lg_u32 s56, 0
  s_cbranch_scc1 L_init_1
  v_lshlrev_b32 v24, 8, v1
  v_mov_b32 v25, 0
  s_mov_b32 s72, 16777216
  buffer_store_dword v25, v24, s[16:19], s72 offen sc0 sc1
  s_waitcnt vmcnt(0)
  v_mov_b32 v24, 0
  v_mov_b32 v25, 1
  s_mov_b64 exec, 1
  buffer_store_dword v25, v24, s[32:35], 0 offen sc0 sc1
  s_mov_b64 exec, -1
L_init_1:
  v_mov_b32 v24, 0
  v_mov_b32 v25, 0
  v_mov_b32 v26, 0
  v_mov_b32 v27, 0
  v_mov_b32 v28, 0
  v_mov_b32 v29, 0
  v_mov_b32 v30, 0
  v_mov_b32 v31, 0
  s_waitcnt vmcnt(12)
  ds_read_b128 v[128:131], v4 offset:0
  ds_read_b128 v[132:135], v5 offset:0
  ds_read_b128 v[136:139], v6 offset:0
  ds_read_b128 v[140:143], v7 offset:0
  ds_read_b128 v[144:147], v4 offset:4096
  ds_read_b128 v[148:151], v5 offset:4096
  ds_read_b128 v[152:155], v6 offset:4096
  ds_read_b128 v[156:159], v7 offset:4096
  ds_read_b128 v[160:163], v4 offset:32768
  ds_read_b128 v[164:167], v5 offset:32768
  ds_read_b128 v[168:171], v6 offset:32768
  ds_read_b128 v[172:175], v7 offset:32768
  ds_read_b128 v[176:179], v4 offset:36864
  ds_read_b128 v[180:183], v5 offset:36864
  ds_read_b128 v[184:187], v6 offset:36864
  ds_read_b128 v[188:191], v7 offset:36864
  s_waitcnt lgkmcnt(8)
  s_barrier
  s_mul_i32 s73, s67, 1
  s_add_u32 s73, s73, s65
  s_add_u32 m0, s66, 0
  v_dot2c_f32_bf16 v24, s79, v128
  buffer_load_dwordx4 v8, s[8:11], s73 offen offset:0 lds
  v_dot2c_f32_bf16 v28, v128, v128
  v_dot2c_f32_bf16 v25, s79, v129
  v_dot2c_f32_bf16 v29, v129, v129
  v_dot2c_f32_bf16 v26, s79, v130
  v_dot2c_f32_bf16 v30, v130, v130
  v_dot2c_f32_bf16 v27, s79, v131
  v_dot2c_f32_bf16 v31, v131, v131
  v_dot2c_f32_bf16 v24, s79, v132
  v_dot2c_f32_bf16 v28, v132, v132
  v_dot2c_f32_bf16 v25, s79, v133
  buffer_load_dwordx4 v9, s[8:11], s73 offen offset:1024 lds
  v_dot2c_f32_bf16 v29, v133, v133
  v_dot2c_f32_bf16 v26, s79, v134
  v_dot2c_f32_bf16 v30, v134, v134
  v_dot2c_f32_bf16 v27, s79, v135
  v_dot2c_f32_bf16 v31, v135, v135
  v_dot2c_f32_bf16 v24, s79, v136
  v_dot2c_f32_bf16 v28, v136, v136
  v_dot2c_f32_bf16 v25, s79, v137
  v_dot2c_f32_bf16 v29, v137, v137
  v_dot2c_f32_bf16 v26, s79, v138
  v_dot2c_f32_bf16 v30, v138, v138
  buffer_load_dwordx4 v10, s[8:11], s73 offen offset:2048 lds
  v_dot2c_f32_bf16 v27, s79, v139
  v_dot2c_f32_bf16 v31, v139, v139
  v_dot2c_f32_bf16 v24, s79, v140
  v_dot2c_f32_bf16 v28, v140, v140
  v_dot2c_f32_bf16 v25, s79, v141
  v_dot2c_f32_bf16 v29, v141, v141
  v_dot2c_f32_bf16 v26, s79, v142
  v_dot2c_f32_bf16 v30, v142, v142
  v_dot2c_f32_bf16 v27, s79, v143
  v_dot2c_f32_bf16 v31, v143, v143
  s_add_u32 s73, s73, s57
  s_add_u32 m0, s66, 3072
  v_dot2c_f32_bf16 v24, s79, v144
  buffer_load_dwordx4 v8, s[8:11], s73 offen offset:0 lds
  v_dot2c_f32_bf16 v28, v144, v144
  v_dot2c_f32_bf16 v25, s79, v145
  v_dot2c_f32_bf16 v29, v145, v145
  v_dot2c_f32_bf16 v26, s79, v146
  v_dot2c_f32_bf16 v30, v146, v146
  v_dot2c_f32_bf16 v27, s79, v147
  v_dot2c_f32_bf16 v31, v147, v147
  v_dot2c_f32_bf16 v24, s79, v148
  v_dot2c_f32_bf16 v28, v148, v148
  v_dot2c_f32_bf16 v25, s79, v149
  buffer_load_dwordx4 v9, s[8:11], s73 offen offset:1024 lds
  v_dot2c_f32_bf16 v29, v149, v149
  v_dot2c_f32_bf16 v26, s79, v150
  v_dot2c_f32_bf16 v30, v150, v150
  v_dot2c_f32_bf16 v27, s79, v151
  v_dot2c_f32_bf16 v31, v151, v151
  v_dot2c_f32_bf16 v24, s79, v152
  v_dot2c_f32_bf16 v28, v152, v152
  v_dot2c_f32_bf16 v25, s79, v153
  v_dot2c_f32_bf16 v29, v153, v153
  v_dot2c_f32_bf16 v26, s79, v154
  v_dot2c_f32_bf16 v30, v154, v154
  buffer_load_dwordx4 v10, s[8:11], s73 offen offset:2048 lds
  v_dot2c_f32_bf16 v27, s79, v155
  v_dot2c_f32_bf16 v31, v155, v155
  v_dot2c_f32_bf16 v24, s79, v156
  v_dot2c_f32_bf16 v28, v156, v156
  v_dot2c_f32_bf16 v25, s79, v157
  v_dot2c_f32_bf16 v29, v157, v157
  v_dot2c_f32_bf16 v26, s79, v158
  v_dot2c_f32_bf16 v30, v158, v158
  v_dot2c_f32_bf16 v27, s79, v159
  v_dot2c_f32_bf16 v31, v159, v159
  v_add_u32 v4, 0x10000, v4
  v_add_u32 v5, 0x10000, v5
  v_add_u32 v6, 0x10000, v6
  v_add_u32 v7, 0x10000, v7
  ds_read_b128 v[192:195], v4 offset:0
  ds_read_b128 v[196:199], v5 offset:0
  ds_read_b128 v[200:203], v6 offset:0
  ds_read_b128 v[204:207], v7 offset:0
  ds_read_b128 v[208:211], v4 offset:4096
  ds_read_b128 v[212:215], v5 offset:4096
  ds_read_b128 v[216:219], v6 offset:4096
  ds_read_b128 v[220:223], v7 offset:4096
  s_waitcnt lgkmcnt(15)
  v_dot2c_f32_bf16 v24, s79, v160
  v_dot2c_f32_bf16 v28, v160, v160
  v_dot2c_f32_bf16 v25, s79, v161
  v_dot2c_f32_bf16 v29, v161, v161
  v_dot2c_f32_bf16 v26, s79, v162
  v_dot2c_f32_bf16 v30, v162, v162
  v_dot2c_f32_bf16 v27, s79, v163
  v_dot2c_f32_bf16 v31, v163, v163
  s_waitcnt lgkmcnt(14)
  v_dot2c_f32_bf16 v24, s79, v164
  v_dot2c_f32_bf16 v28, v164, v164
  v_dot2c_f32_bf16 v25, s79, v165
  v_dot2c_f32_bf16 v29, v165, v165
  v_dot2c_f32_bf16 v26, s79, v166
  v_dot2c_f32_bf16 v30, v166, v166
  v_dot2c_f32_bf16 v27, s79, v167
  v_dot2c_f32_bf16 v31, v167, v167
  s_waitcnt lgkmcnt(13)
  v_dot2c_f32_bf16 v24, s79, v168
  v_dot2c_f32_bf16 v28, v168, v168
  v_dot2c_f32_bf16 v25, s79, v169
  v_dot2c_f32_bf16 v29, v169, v169
  v_dot2c_f32_bf16 v26, s79, v170
  v_dot2c_f32_bf16 v30, v170, v170
  v_dot2c_f32_bf16 v27, s79, v171
  v_dot2c_f32_bf16 v31, v171, v171
  s_waitcnt lgkmcnt(12)
  v_dot2c_f32_bf16 v24, s79, v172
  v_dot2c_f32_bf16 v28, v172, v172
  v_dot2c_f32_bf16 v25, s79, v173
  v_dot2c_f32_bf16 v29, v173, v173
  v_dot2c_f32_bf16 v26, s79, v174
  v_dot2c_f32_bf16 v30, v174, v174
  v_dot2c_f32_bf16 v27, s79, v175
  v_dot2c_f32_bf16 v31, v175, v175
  s_waitcnt lgkmcnt(11)
  v_dot2c_f32_bf16 v24, s79, v176
  v_dot2c_f32_bf16 v28, v176, v176
  v_dot2c_f32_bf16 v25, s79, v177
  v_dot2c_f32_bf16 v29, v177, v177
  v_dot2c_f32_bf16 v26, s79, v178
  v_dot2c_f32_bf16 v30, v178, v178
  v_dot2c_f32_bf16 v27, s79, v179
  v_dot2c_f32_bf16 v31, v179, v179
  s_waitcnt lgkmcnt(10)
  v_dot2c_f32_bf16 v24, s79, v180
  v_dot2c_f32_bf16 v28, v180, v180
  v_dot2c_f32_bf16 v25, s79, v181
  v_dot2c_f32_bf16 v29, v181, v181
  v_dot2c_f32_bf16 v26, s79, v182
  v_dot2c_f32_bf16 v30, v182, v182
  v_dot2c_f32_bf16 v27, s79, v183
  v_dot2c_f32_bf16 v31, v183, v183
  s_waitcnt lgkmcnt(9)
  v_dot2c_f32_bf16 v24, s79, v184
  v_dot2c_f32_bf16 v28, v184, v184
  v_dot2c_f32_bf16 v25, s79, v185
  v_dot2c_f32_bf16 v29, v185, v185
  v_dot2c_f32_bf16 v26, s79, v186
  v_dot2c_f32_bf16 v30, v186, v186
  v_dot2c_f32_bf16 v27, s79, v187
  v_dot2c_f32_bf16 v31, v187, v187
  s_waitcnt lgkmcnt(8)
  v_dot2c_f32_bf16 v24, s79, v188
  v_dot2c_f32_bf16 v28, v188, v188
  v_dot2c_f32_bf16 v25, s79, v189
  v_dot2c_f32_bf16 v29, v189, v189
  v_dot2c_f32_bf16 v26, s79, v190
  v_dot2c_f32_bf16 v30, v190, v190
  v_dot2c_f32_bf16 v27, s79, v191
  v_dot2c_f32_bf16 v31, v191, v191
  ds_read_b128 v[224:227], v4 offset:32768
  ds_read_b128 v[228:231], v5 offset:32768
  ds_read_b128 v[232:235], v6 offset:32768
  ds_read_b128 v[236:239], v7 offset:32768
  ds_read_b128 v[240:243], v4 offset:36864
  ds_read_b128 v[244:247], v5 offset:36864
  ds_read_b128 v[248:251], v6 offset:36864
  ds_read_b128 v[252:255], v7 offset:36864
  s_waitcnt lgkmcnt(15)
  v_dot2c_f32_bf16 v24, s79, v192
  v_dot2c_f32_bf16 v28, v192, v192
  v_dot2c_f32_bf16 v25, s79, v193
  v_dot2c_f32_bf16 v29, v193, v193
  v_dot2c_f32_bf16 v26, s79, v194
  v_dot2c_f32_bf16 v30, v194, v194
  v_dot2c_f32_bf16 v27, s79, v195
  v_dot2c_f32_bf16 v31, v195, v195
  s_waitcnt lgkmcnt(14)
  v_dot2c_f32_bf16 v24, s79, v196
  v_dot2c_f32_bf16 v28, v196, v196
  v_dot2c_f32_bf16 v25, s79, v197
  v_dot2c_f32_bf16 v29, v197, v197
  v_dot2c_f32_bf16 v26, s79, v198
  v_dot2c_f32_bf16 v30, v198, v198
  v_dot2c_f32_bf16 v27, s79, v199
  v_dot2c_f32_bf16 v31, v199, v199
  s_waitcnt lgkmcnt(13)
  v_dot2c_f32_bf16 v24, s79, v200
  v_dot2c_f32_bf16 v28, v200, v200
  v_dot2c_f32_bf16 v25, s79, v201
  v_dot2c_f32_bf16 v29, v201, v201
  v_dot2c_f32_bf16 v26, s79, v202
  v_dot2c_f32_bf16 v30, v202, v202
  v_dot2c_f32_bf16 v27, s79, v203
  v_dot2c_f32_bf16 v31, v203, v203
  s_waitcnt lgkmcnt(12)
  v_dot2c_f32_bf16 v24, s79, v204
  v_dot2c_f32_bf16 v28, v204, v204
  v_dot2c_f32_bf16 v25, s79, v205
  v_dot2c_f32_bf16 v29, v205, v205
  v_dot2c_f32_bf16 v26, s79, v206
  v_dot2c_f32_bf16 v30, v206, v206
  v_dot2c_f32_bf16 v27, s79, v207
  v_dot2c_f32_bf16 v31, v207, v207
  s_waitcnt lgkmcnt(11)
  v_dot2c_f32_bf16 v24, s79, v208
  v_dot2c_f32_bf16 v28, v208, v208
  v_dot2c_f32_bf16 v25, s79, v209
  v_dot2c_f32_bf16 v29, v209, v209
  v_dot2c_f32_bf16 v26, s79, v210
  v_dot2c_f32_bf16 v30, v210, v210
  v_dot2c_f32_bf16 v27, s79, v211
  v_dot2c_f32_bf16 v31, v211, v211
  s_waitcnt lgkmcnt(10)
  v_dot2c_f32_bf16 v24, s79, v212
  v_dot2c_f32_bf16 v28, v212, v212
  v_dot2c_f32_bf16 v25, s79, v213
  v_dot2c_f32_bf16 v29, v213, v213
  v_dot2c_f32_bf16 v26, s79, v214
  v_dot2c_f32_bf16 v30, v214, v214
  v_dot2c_f32_bf16 v27, s79, v215
  v_dot2c_f32_bf16 v31, v215, v215
  s_waitcnt lgkmcnt(9)
  v_dot2c_f32_bf16 v24, s79, v216
  v_dot2c_f32_bf16 v28, v216, v216
  v_dot2c_f32_bf16 v25, s79, v217
  v_dot2c_f32_bf16 v29, v217, v217
  v_dot2c_f32_bf16 v26, s79, v218
  v_dot2c_f32_bf16 v30, v218, v218
  v_dot2c_f32_bf16 v27, s79, v219
  v_dot2c_f32_bf16 v31, v219, v219
  s_waitcnt lgkmcnt(8)
  v_dot2c_f32_bf16 v24, s79, v220
  v_dot2c_f32_bf16 v28, v220, v220
  v_dot2c_f32_bf16 v25, s79, v221
  v_dot2c_f32_bf16 v29, v221, v221
  v_dot2c_f32_bf16 v26, s79, v222
  v_dot2c_f32_bf16 v30, v222, v222
  v_dot2c_f32_bf16 v27, s79, v223
  v_dot2c_f32_bf16 v31, v223, v223
  s_waitcnt lgkmcnt(7)
  v_dot2c_f32_bf16 v24, s79, v224
  v_dot2c_f32_bf16 v28, v224, v224
  v_dot2c_f32_bf16 v25, s79, v225
  v_dot2c_f32_bf16 v29, v225, v225
  v_dot2c_f32_bf16 v26, s79, v226
  v_dot2c_f32_bf16 v30, v226, v226
  v_dot2c_f32_bf16 v27, s79, v227
  v_dot2c_f32_bf16 v31, v227, v227
  s_waitcnt lgkmcnt(6)
  v_dot2c_f32_bf16 v24, s79, v228
  v_dot2c_f32_bf16 v28, v228, v228
  v_dot2c_f32_bf16 v25, s79, v229
  v_dot2c_f32_bf16 v29, v229, v229
  v_dot2c_f32_bf16 v26, s79, v230
  v_dot2c_f32_bf16 v30, v230, v230
  v_dot2c_f32_bf16 v27, s79, v231
  v_dot2c_f32_bf16 v31, v231, v231
  s_waitcnt lgkmcnt(5)
  v_dot2c_f32_bf16 v24, s79, v232
  v_dot2c_f32_bf16 v28, v232, v232
  v_dot2c_f32_bf16 v25, s79, v233
  v_dot2c_f32_bf16 v29, v233, v233
  v_dot2c_f32_bf16 v26, s79, v234
  v_dot2c_f32_bf16 v30, v234, v234
  v_dot2c_f32_bf16 v27, s79, v235
  v_dot2c_f32_bf16 v31, v235, v235
  s_waitcnt lgkmcnt(4)
  v_dot2c_f32_bf16 v24, s79, v236
  v_dot2c_f32_bf16 v28, v236, v236
  v_dot2c_f32_bf16 v25, s79, v237
  v_dot2c_f32_bf16 v29, v237, v237
  v_dot2c_f32_bf16 v26, s79, v238
  v_dot2c_f32_bf16 v30, v238, v238
  v_dot2c_f32_bf16 v27, s79, v239
  v_dot2c_f32_bf16 v31, v239, v239
  s_waitcnt lgkmcnt(3)
  v_dot2c_f32_bf16 v24, s79, v240
  v_dot2c_f32_bf16 v28, v240, v240
  v_dot2c_f32_bf16 v25, s79, v241
  v_dot2c_f32_bf16 v29, v241, v241
  v_dot2c_f32_bf16 v26, s79, v242
  v_dot2c_f32_bf16 v30, v242, v242
  v_dot2c_f32_bf16 v27, s79, v243
  v_dot2c_f32_bf16 v31, v243, v243
  s_waitcnt lgkmcnt(2)
  v_dot2c_f32_bf16 v24, s79, v244
  v_dot2c_f32_bf16 v28, v244, v244
  v_dot2c_f32_bf16 v25, s79, v245
  v_dot2c_f32_bf16 v29, v245, v245
  v_dot2c_f32_bf16 v26, s79, v246
  v_dot2c_f32_bf16 v30, v246, v246
  v_dot2c_f32_bf16 v27, s79, v247
  v_dot2c_f32_bf16 v31, v247, v247
  s_waitcnt lgkmcnt(1)
  v_dot2c_f32_bf16 v24, s79, v248
  v_dot2c_f32_bf16 v28, v248, v248
  v_dot2c_f32_bf16 v25, s79, v249
  v_dot2c_f32_bf16 v29, v249, v249
  v_dot2c_f32_bf16 v26, s79, v250
  v_dot2c_f32_bf16 v30, v250, v250
  v_dot2c_f32_bf16 v27, s79, v251
  v_dot2c_f32_bf16 v31, v251, v251
  s_waitcnt lgkmcnt(0)
  v_dot2c_f32_bf16 v24, s79, v252
  v_dot2c_f32_bf16 v28, v252, v252
  v_dot2c_f32_bf16 v25, s79, v253
  v_dot2c_f32_bf16 v29, v253, v253
  v_dot2c_f32_bf16 v26, s79, v254
  v_dot2c_f32_bf16 v30, v254, v254
  v_dot2c_f32_bf16 v27, s79, v255
  v_dot2c_f32_bf16 v31, v255, v255
  v_add_f32 v24, v24, v25
  s_nop 0
  v_add_f32 v26, v26, v27
  v_add_f32 v28, v28, v29
  v_add_f32 v30, v30, v31
  v_add_f32 v24, v24, v26
  v_add_f32 v25, v28, v30
  v_mov_b32 v26, v24
  v_mov_b32 v27, v25
  s_nop 0
  v_permlane32_swap_b32 v24, v26
  v_permlane32_swap_b32 v25, v27
  v_add_f32 v24, v24, v26
  v_add_f32 v25, v25, v27
  v_mul_f32 v24, 0x3b000000, v24
  v_mul_f32 v25, 0x3b000000, v25
  v_fma_f32 v25, -v24, v24, v25
  v_max_f32 v25, 0, v25
  v_cvt_pk_bf16_f32 v26, v24, v25
  v_and_b32 v25, v20, v26
  v_lshlrev_b32 v24, 16, v26
  v_add_f32 v25, 0x3727c5ac, v25
  v_cvt_pk_bf16_f32 v25, v25, v25
  v_and_b32 v25, v20, v25
  v_sqrt_f32 v25, v25
  s_nop 0
  v_cvt_pk_bf16_f32 v25, v25, v25
  v_and_b32 v25, v20, v25
  v_rcp_f32 v18, v25
  s_nop 0
  v_mul_f32 v19, v24, v18
  v_sub_f32 v19, 0, v19
  s_mov_b32 s28, s50
  s_mov_b32 s29, s51
  s_mov_b32 s30, 0x00200000
  s_mov_b32 s31, 0x20000
  v_lshlrev_b32 v24, 16, v128
  v_and_b32 v25, v20, v128
  v_lshlrev_b32 v26, 16, v129
  v_and_b32 v27, v20, v129
  v_fma_f32 v24, v24, v18, v19
  v_fma_f32 v25, v25, v18, v19
  v_fma_f32 v26, v26, v18, v19
  v_fma_f32 v27, v27, v18, v19
  v_cvt_pk_bf16_f32 v128, v24, v25
  v_cvt_pk_bf16_f32 v129, v26, v27
  v_lshlrev_b32 v28, 16, v130
  v_and_b32 v29, v20, v130
  v_lshlrev_b32 v30, 16, v131
  v_and_b32 v31, v20, v131
  v_fma_f32 v28, v28, v18, v19
  v_fma_f32 v29, v29, v18, v19
  v_fma_f32 v30, v30, v18, v19
  v_fma_f32 v31, v31, v18, v19
  v_cvt_pk_bf16_f32 v130, v28, v29
  v_cvt_pk_bf16_f32 v131, v30, v31
  v_lshlrev_b32 v24, 16, v132
  v_and_b32 v25, v20, v132
  v_lshlrev_b32 v26, 16, v133
  v_and_b32 v27, v20, v133
  v_fma_f32 v24, v24, v18, v19
  v_fma_f32 v25, v25, v18, v19
  v_fma_f32 v26, v26, v18, v19
  v_fma_f32 v27, v27, v18, v19
  v_cvt_pk_bf16_f32 v132, v24, v25
  v_cvt_pk_bf16_f32 v133, v26, v27
  v_lshlrev_b32 v28, 16, v134
  v_and_b32 v29, v20, v134
  v_lshlrev_b32 v30, 16, v135
  v_and_b32 v31, v20, v135
  v_fma_f32 v28, v28, v18, v19
  v_fma_f32 v29, v29, v18, v19
  v_fma_f32 v30, v30, v18, v19
  v_fma_f32 v31, v31, v18, v19
  v_cvt_pk_bf16_f32 v134, v28, v29
  v_cvt_pk_bf16_f32 v135, v30, v31
  s_waitcnt vmcnt(12)
  s_barrier
  ds_read_b64_tr_b16 a[64:65], v12 offset:0
  ds_read_b64_tr_b16 a[66:67], v12 offset:768
  ds_read_b64_tr_b16 a[68:69], v12 offset:64
  ds_read_b64_tr_b16 a[70:71], v12 offset:832
  ds_read_b64_tr_b16 a[72:73], v12 offset:128
  ds_read_b64_tr_b16 a[74:75], v12 offset:896
  ds_read_b64_tr_b16 a[76:77], v13 offset:0
  ds_read_b64_tr_b16 a[78:79], v13 offset:384
  ds_read_b64_tr_b16 a[80:81], v13 offset:32
  ds_read_b64_tr_b16 a[82:83], v13 offset:416
  ds_read_b64_tr_b16 a[84:85], v13 offset:64
  ds_read_b64_tr_b16 a[86:87], v13 offset:448
  ds_read_b64_tr_b16 a[88:89], v12 offset:3072
  ds_read_b64_tr_b16 a[90:91], v12 offset:3840
  ds_read_b64_tr_b16 a[92:93], v12 offset:3136
  ds_read_b64_tr_b16 a[94:95], v12 offset:3904
  ds_read_b64_tr_b16 a[96:97], v12 offset:3200
  ds_read_b64_tr_b16 a[98:99], v12 offset:3968
  ds_read_b64_tr_b16 a[100:101], v13 offset:1536
  ds_read_b64_tr_b16 a[102:103], v13 offset:1920
  ds_read_b64_tr_b16 a[104:105], v13 offset:1568
  ds_read_b64_tr_b16 a[106:107], v13 offset:1952
  ds_read_b64_tr_b16 a[108:109], v13 offset:1600
  ds_read_b64_tr_b16 a[110:111], v13 offset:1984
  v_add_u32 v4, 27648, v11
  v_add_u32 v5, 55296, v11
  v_add_u32 v6, 82944, v11
  s_waitcnt lgkmcnt(12)
  v_mfma_f32_32x32x16_bf16 v[32:47], a[64:67], v[128:131], 0
  ds_read_b64_tr_b16 a[112:113], v12 offset:6144
  ds_read_b64_tr_b16 a[114:115], v12 offset:6912
  v_lshlrev_b32 v24, 16, v136
  v_and_b32 v25, v20, v136
  v_lshlrev_b32 v26, 16, v137
  v_mfma_f32_32x32x16_bf16 v[48:63], a[68:71], v[128:131], 0
  ds_read_b64_tr_b16 a[116:117], v12 offset:6208
  ds_read_b64_tr_b16 a[118:119], v12 offset:6976
  v_and_b32 v27, v20, v137
  v_fma_f32 v24, v24, v18, v19
  v_fma_f32 v25, v25, v18, v19
  s_mul_i32 s73, s67, 2
  s_add_u32 s73, s73, s65
  s_add_u32 m0, s66, 32768
  v_mfma_f32_32x32x16_bf16 v[64:79], v[128:131], a[72:75], 0
  buffer_load_dwordx4 v8, s[8:11], s73 offen offset:0 lds
  ds_read_b64_tr_b16 a[120:121], v12 offset:6272
  ds_read_b64_tr_b16 a[122:123], v12 offset:7040
  v_fma_f32 v26, v26, v18, v19
  v_fma_f32 v27, v27, v18, v19
  v_cvt_pk_bf16_f32 v136, v24, v25
  v_mfma_f32_32x32x16_bf16 v[80:95], a[76:79], v[128:131], 0
  ds_read_b64_tr_b16 a[124:125], v13 offset:3072
  ds_read_b64_tr_b16 a[126:127], v13 offset:3456
  v_cvt_pk_bf16_f32 v137, v26, v27
  v_lshlrev_b32 v28, 16, v138
  v_and_b32 v29, v20, v138
  v_mfma_f32_32x32x16_bf16 v[96:111], a[80:83], v[128:131], 0
  ds_read_b64_tr_b16 a[128:129], v13 offset:3104
  ds_read_b64_tr_b16 a[130:131], v13 offset:3488
  v_lshlrev_b32 v30, 16, v139
  v_and_b32 v31, v20, v139
  v_fma_f32 v28, v28, v18, v19
  v_fma_f32 v29, v29, v18, v19
  v_mfma_f32_32x32x16_bf16 v[112:127], a[84:87], v[128:131], 0
  buffer_load_dwordx4 v9, s[8:11], s73 offen offset:1024 lds
  ds_read_b64_tr_b16 a[132:133], v13 offset:3136
  ds_read_b64_tr_b16 a[134:135], v13 offset:3520
  v_fma_f32 v30, v30, v18, v19
  v_fma_f32 v31, v31, v18, v19
  v_cvt_pk_bf16_f32 v138, v28, v29
  v_cvt_pk_bf16_f32 v139, v30, v31
  s_waitcnt lgkmcnt(12)
  v_mfma_f32_32x32x16_bf16 v[32:47], a[88:91], v[132:135], v[32:47]
  ds_read_b64_tr_b16 a[64:65], v12 offset:9216
  ds_read_b64_tr_b16 a[66:67], v12 offset:9984
  v_lshlrev_b32 v24, 16, v140
  v_and_b32 v25, v20, v140
  v_lshlrev_b32 v26, 16, v141
  v_mfma_f32_32x32x16_bf16 v[48:63], a[92:95], v[132:135], v[48:63]
  ds_read_b64_tr_b16 a[68:69], v12 offset:9280
  ds_read_b64_tr_b16 a[70:71], v12 offset:10048
  v_and_b32 v27, v20, v141
  v_fma_f32 v24, v24, v18, v19
  v_fma_f32 v25, v25, v18, v19
  v_mfma_f32_32x32x16_bf16 v[64:79], v[132:135], a[96:99], v[64:79]
  buffer_load_dwordx4 v10, s[8:11], s73 offen offset:2048 lds
  ds_read_b64_tr_b16 a[72:73], v12 offset:9344
  ds_read_b64_tr_b16 a[74:75], v12 offset:10112
  v_fma_f32 v26, v26, v18, v19
  v_fma_f32 v27, v27, v18, v19
  v_cvt_pk_bf16_f32 v140, v24, v25
  v_mfma_f32_32x32x16_bf16 v[80:95], a[100:103], v[132:135], v[80:95]
  ds_read_b64_tr_b16 a[76:77], v13 offset:4608
  ds_read_b64_tr_b16 a[78:79], v13 offset:4992
  v_cvt_pk_bf16_f32 v141, v26, v27
  v_lshlrev_b32 v28, 16, v142
  v_and_b32 v29, v20, v142
  v_mfma_f32_32x32x16_bf16 v[96:111], a[104:107], v[132:135], v[96:111]
  ds_read_b64_tr_b16 a[80:81], v13 offset:4640
  ds_read_b64_tr_b16 a[82:83], v13 offset:5024
  v_lshlrev_b32 v30, 16, v143
  v_and_b32 v31, v20, v143
  v_fma_f32 v28, v28, v18, v19
  v_fma_f32 v29, v29, v18, v19
  s_add_u32 s73, s73, s57
  s_add_u32 m0, s66, 35840
  v_mfma_f32_32x32x16_bf16 v[112:127], a[108:111], v[132:135], v[112:127]
  buffer_load_dwordx4 v8, s[8:11], s73 offen offset:0 lds
  ds_read_b64_tr_b16 a[84:85], v13 offset:4672
  ds_read_b64_tr_b16 a[86:87], v13 offset:5056
  v_fma_f32 v30, v30, v18, v19
  v_fma_f32 v31, v31, v18, v19
  v_cvt_pk_bf16_f32 v142, v28, v29
  v_cvt_pk_bf16_f32 v143, v30, v31
  s_waitcnt lgkmcnt(12)
  v_mfma_f32_32x32x16_bf16 v[32:47], a[112:115], v[136:139], v[32:47]
  s_waitcnt vmcnt(4)
  s_barrier
  v_add_u32 v12, 0xfffe0000, v12
  v_add_u32 v13, 0xfffe0000, v13
  ds_read_b64_tr_b16 a[88:89], v12 offset:0
  ds_read_b64_tr_b16 a[90:91], v12 offset:768
  v_lshlrev_b32 v24, 16, v144
  v_and_b32 v25, v20, v144
  v_lshlrev_b32 v26, 16, v145
  v_mfma_f32_32x32x16_bf16 v[48:63], a[116:119], v[136:139], v[48:63]
  ds_read_b64_tr_b16 a[92:93], v12 offset:64
  ds_read_b64_tr_b16 a[94:95], v12 offset:832
  v_and_b32 v27, v20, v145
  v_fma_f32 v24, v24, v18, v19
  v_fma_f32 v25, v25, v18, v19
  v_mfma_f32_32x32x16_bf16 v[64:79], v[136:139], a[120:123], v[64:79]
  buffer_load_dwordx4 v9, s[8:11], s73 offen offset:1024 lds
  ds_read_b64_tr_b16 a[96:97], v12 offset:128
  ds_read_b64_tr_b16 a[98:99], v12 offset:896
  v_fma_f32 v26, v26, v18, v19
  v_fma_f32 v27, v27, v18, v19
  v_cvt_pk_bf16_f32 v144, v24, v25
  v_mfma_f32_32x32x16_bf16 v[80:95], a[124:127], v[136:139], v[80:95]
  ds_read_b64_tr_b16 a[100:101], v13 offset:0
  ds_read_b64_tr_b16 a[102:103], v13 offset:384
  v_cvt_pk_bf16_f32 v145, v26, v27
  v_lshlrev_b32 v28, 16, v146
  v_and_b32 v29, v20, v146
  v_mfma_f32_32x32x16_bf16 v[96:111], a[128:131], v[136:139], v[96:111]
  ds_read_b64_tr_b16 a[104:105], v13 offset:32
  ds_read_b64_tr_b16 a[106:107], v13 offset:416
  v_lshlrev_b32 v30, 16, v147
  v_and_b32 v31, v20, v147
  v_fma_f32 v28, v28, v18, v19
  v_fma_f32 v29, v29, v18, v19
  v_mfma_f32_32x32x16_bf16 v[112:127], a[132:135], v[136:139], v[112:127]
  buffer_load_dwordx4 v10, s[8:11], s73 offen offset:2048 lds
  ds_read_b64_tr_b16 a[108:109], v13 offset:64
  ds_read_b64_tr_b16 a[110:111], v13 offset:448
  v_fma_f32 v30, v30, v18, v19
  v_fma_f32 v31, v31, v18, v19
  v_cvt_pk_bf16_f32 v146, v28, v29
  v_cvt_pk_bf16_f32 v147, v30, v31
  s_waitcnt lgkmcnt(12)
  v_mfma_f32_32x32x16_bf16 v[32:47], a[64:67], v[140:143], v[32:47]
  ds_read_b64_tr_b16 a[112:113], v12 offset:3072
  ds_read_b64_tr_b16 a[114:115], v12 offset:3840
  v_lshlrev_b32 v24, 16, v148
  v_and_b32 v25, v20, v148
  v_lshlrev_b32 v26, 16, v149
  v_mfma_f32_32x32x16_bf16 v[48:63], a[68:71], v[140:143], v[48:63]
  ds_read_b64_tr_b16 a[116:117], v12 offset:3136
  ds_read_b64_tr_b16 a[118:119], v12 offset:3904
  v_and_b32 v27, v20, v149
  v_fma_f32 v24, v24, v18, v19
  v_fma_f32 v25, v25, v18, v19
  s_mul_i32 s73, s67, 3
  s_add_u32 s73, s73, s65
  s_add_u32 m0, s66, 65536
  v_mfma_f32_32x32x16_bf16 v[64:79], v[140:143], a[72:75], v[64:79]
  buffer_load_dwordx4 v8, s[8:11], s73 offen offset:0 lds
  ds_read_b64_tr_b16 a[120:121], v12 offset:3200
  ds_read_b64_tr_b16 a[122:123], v12 offset:3968
  v_fma_f32 v26, v26, v18, v19
  v_fma_f32 v27, v27, v18, v19
  v_cvt_pk_bf16_f32 v148, v24, v25
  v_mfma_f32_32x32x16_bf16 v[80:95], a[76:79], v[140:143], v[80:95]
  ds_read_b64_tr_b16 a[124:125], v13 offset:1536
  ds_read_b64_tr_b16 a[126:127], v13 offset:1920
  v_cvt_pk_bf16_f32 v149, v26, v27
  v_lshlrev_b32 v28, 16, v150
  v_and_b32 v29, v20, v150
  v_mfma_f32_32x32x16_bf16 v[96:111], a[80:83], v[140:143], v[96:111]
  ds_read_b64_tr_b16 a[128:129], v13 offset:1568
  ds_read_b64_tr_b16 a[130:131], v13 offset:1952
  v_lshlrev_b32 v30, 16, v151
  v_and_b32 v31, v20, v151
  v_fma_f32 v28, v28, v18, v19
  v_fma_f32 v29, v29, v18, v19
  v_mfma_f32_32x32x16_bf16 v[112:127], a[84:87], v[140:143], v[112:127]
  buffer_load_dwordx4 v9, s[8:11], s73 offen offset:1024 lds
  ds_read_b64_tr_b16 a[132:133], v13 offset:1600
  ds_read_b64_tr_b16 a[134:135], v13 offset:1984
  v_fma_f32 v30, v30, v18, v19
  v_fma_f32 v31, v31, v18, v19
  v_cvt_pk_bf16_f32 v150, v28, v29
  v_cvt_pk_bf16_f32 v151, v30, v31
  s_waitcnt lgkmcnt(12)
  v_mfma_f32_32x32x16_bf16 v[32:47], a[88:91], v[144:147], v[32:47]
  ds_read_b64_tr_b16 a[64:65], v12 offset:6144
  ds_read_b64_tr_b16 a[66:67], v12 offset:6912
  v_lshlrev_b32 v24, 16, v152
  v_and_b32 v25, v20, v152
  v_lshlrev_b32 v26, 16, v153
  v_mfma_f32_32x32x16_bf16 v[48:63], a[92:95], v[144:147], v[48:63]
  ds_read_b64_tr_b16 a[68:69], v12 offset:6208
  ds_read_b64_tr_b16 a[70:71], v12 offset:6976
  v_and_b32 v27, v20, v153
  v_fma_f32 v24, v24, v18, v19
  v_fma_f32 v25, v25, v18, v19
  v_mfma_f32_32x32x16_bf16 v[64:79], v[144:147], a[96:99], v[64:79]
  buffer_load_dwordx4 v10, s[8:11], s73 offen offset:2048 lds
  ds_read_b64_tr_b16 a[72:73], v12 offset:6272
  ds_read_b64_tr_b16 a[74:75], v12 offset:7040
  v_fma_f32 v26, v26, v18, v19
  v_fma_f32 v27, v27, v18, v19
  v_cvt_pk_bf16_f32 v152, v24, v25
  v_mfma_f32_32x32x16_bf16 v[80:95], a[100:103], v[144:147], v[80:95]
  ds_read_b64_tr_b16 a[76:77], v13 offset:3072
  ds_read_b64_tr_b16 a[78:79], v13 offset:3456
  v_cvt_pk_bf16_f32 v153, v26, v27
  v_lshlrev_b32 v28, 16, v154
  v_and_b32 v29, v20, v154
  v_mfma_f32_32x32x16_bf16 v[96:111], a[104:107], v[144:147], v[96:111]
  ds_read_b64_tr_b16 a[80:81], v13 offset:3104
  ds_read_b64_tr_b16 a[82:83], v13 offset:3488
  v_lshlrev_b32 v30, 16, v155
  v_and_b32 v31, v20, v155
  v_fma_f32 v28, v28, v18, v19
  v_fma_f32 v29, v29, v18, v19
  s_add_u32 s73, s73, s57
  s_add_u32 m0, s66, 68608
  v_mfma_f32_32x32x16_bf16 v[112:127], a[108:111], v[144:147], v[112:127]
  buffer_load_dwordx4 v8, s[8:11], s73 offen offset:0 lds
  ds_read_b64_tr_b16 a[84:85], v13 offset:3136
  ds_read_b64_tr_b16 a[86:87], v13 offset:3520
  v_fma_f32 v30, v30, v18, v19
  v_fma_f32 v31, v31, v18, v19
  v_cvt_pk_bf16_f32 v154, v28, v29
  v_cvt_pk_bf16_f32 v155, v30, v31
  s_waitcnt lgkmcnt(12)
  v_mfma_f32_32x32x16_bf16 v[32:47], a[112:115], v[148:151], v[32:47]
  ds_read_b64_tr_b16 a[88:89], v12 offset:9216
  ds_read_b64_tr_b16 a[90:91], v12 offset:9984
  v_lshlrev_b32 v24, 16, v156
  v_and_b32 v25, v20, v156
  v_lshlrev_b32 v26, 16, v157
  v_mfma_f32_32x32x16_bf16 v[48:63], a[116:119], v[148:151], v[48:63]
  ds_read_b64_tr_b16 a[92:93], v12 offset:9280
  ds_read_b64_tr_b16 a[94:95], v12 offset:10048
  v_and_b32 v27, v20, v157
  v_fma_f32 v24, v24, v18, v19
  v_fma_f32 v25, v25, v18, v19
  v_mfma_f32_32x32x16_bf16 v[64:79], v[148:151], a[120:123], v[64:79]
  buffer_load_dwordx4 v9, s[8:11], s73 offen offset:1024 lds
  ds_read_b64_tr_b16 a[96:97], v12 offset:9344
  ds_read_b64_tr_b16 a[98:99], v12 offset:10112
  v_fma_f32 v26, v26, v18, v19
  v_fma_f32 v27, v27, v18, v19
  v_cvt_pk_bf16_f32 v156, v24, v25
  v_mfma_f32_32x32x16_bf16 v[80:95], a[124:127], v[148:151], v[80:95]
  ds_read_b64_tr_b16 a[100:101], v13 offset:4608
  ds_read_b64_tr_b16 a[102:103], v13 offset:4992
  v_cvt_pk_bf16_f32 v157, v26, v27
  v_lshlrev_b32 v28, 16, v158
  v_and_b32 v29, v20, v158
  v_mfma_f32_32x32x16_bf16 v[96:111], a[128:131], v[148:151], v[96:111]
  ds_read_b64_tr_b16 a[104:105], v13 offset:4640
  ds_read_b64_tr_b16 a[106:107], v13 offset:5024
  v_lshlrev_b32 v30, 16, v159
  v_and_b32 v31, v20, v159
  v_fma_f32 v28, v28, v18, v19
  v_fma_f32 v29, v29, v18, v19
  v_mfma_f32_32x32x16_bf16 v[112:127], a[132:135], v[148:151], v[112:127]
  buffer_load_dwordx4 v10, s[8:11], s73 offen offset:2048 lds
  ds_read_b64_tr_b16 a[108:109], v13 offset:4672
  ds_read_b64_tr_b16 a[110:111], v13 offset:5056
  v_fma_f32 v30, v30, v18, v19
  v_fma_f32 v31, v31, v18, v19
  v_cvt_pk_bf16_f32 v158, v28, v29
  v_cvt_pk_bf16_f32 v159, v30, v31
  s_waitcnt lgkmcnt(12)
  v_mfma_f32_32x32x16_bf16 v[32:47], a[64:67], v[152:155], v[32:47]
  s_waitcnt vmcnt(6)
  s_barrier
  v_add_u32 v12, 0x00008000, v12
  v_add_u32 v13, 0x00008000, v13
  ds_read_b64_tr_b16 a[112:113], v12 offset:0
  ds_read_b64_tr_b16 a[114:115], v12 offset:768
  v_lshlrev_b32 v24, 16, v160
  v_and_b32 v25, v20, v160
  v_lshlrev_b32 v26, 16, v161
  v_mfma_f32_32x32x16_bf16 v[48:63], a[68:71], v[152:155], v[48:63]
  ds_read_b64_tr_b16 a[116:117], v12 offset:64
  ds_read_b64_tr_b16 a[118:119], v12 offset:832
  v_and_b32 v27, v20, v161
  v_fma_f32 v24, v24, v18, v19
  v_fma_f32 v25, v25, v18, v19
  s_mul_i32 s73, s67, 4
  s_add_u32 s73, s73, s65
  s_add_u32 m0, s66, 98304
  v_mfma_f32_32x32x16_bf16 v[64:79], v[152:155], a[72:75], v[64:79]
  buffer_load_dwordx4 v8, s[8:11], s73 offen offset:0 lds
  ds_read_b64_tr_b16 a[120:121], v12 offset:128
  ds_read_b64_tr_b16 a[122:123], v12 offset:896
  v_fma_f32 v26, v26, v18, v19
  v_fma_f32 v27, v27, v18, v19
  v_cvt_pk_bf16_f32 v160, v24, v25
  v_mfma_f32_32x32x16_bf16 v[80:95], a[76:79], v[152:155], v[80:95]
  ds_read_b64_tr_b16 a[124:125], v13 offset:0
  ds_read_b64_tr_b16 a[126:127], v13 offset:384
  v_cvt_pk_bf16_f32 v161, v26, v27
  v_lshlrev_b32 v28, 16, v162
  v_and_b32 v29, v20, v162
  v_mfma_f32_32x32x16_bf16 v[96:111], a[80:83], v[152:155], v[96:111]
  ds_read_b64_tr_b16 a[128:129], v13 offset:32
  ds_read_b64_tr_b16 a[130:131], v13 offset:416
  v_lshlrev_b32 v30, 16, v163
  v_and_b32 v31, v20, v163
  v_fma_f32 v28, v28, v18, v19
  v_fma_f32 v29, v29, v18, v19
  v_mfma_f32_32x32x16_bf16 v[112:127], a[84:87], v[152:155], v[112:127]
  buffer_load_dwordx4 v9, s[8:11], s73 offen offset:1024 lds
  ds_read_b64_tr_b16 a[132:133], v13 offset:64
  ds_read_b64_tr_b16 a[134:135], v13 offset:448
  v_fma_f32 v30, v30, v18, v19
  v_fma_f32 v31, v31, v18, v19
  v_cvt_pk_bf16_f32 v162, v28, v29
  v_cvt_pk_bf16_f32 v163, v30, v31
  s_waitcnt lgkmcnt(12)
  v_mfma_f32_32x32x16_bf16 v[32:47], a[88:91], v[156:159], v[32:47]
  ds_read_b64_tr_b16 a[64:65], v12 offset:3072
  ds_read_b64_tr_b16 a[66:67], v12 offset:3840
  v_lshlrev_b32 v24, 16, v164
  v_and_b32 v25, v20, v164
  v_lshlrev_b32 v26, 16, v165
  v_mfma_f32_32x32x16_bf16 v[48:63], a[92:95], v[156:159], v[48:63]
  ds_read_b64_tr_b16 a[68:69], v12 offset:3136
  ds_read_b64_tr_b16 a[70:71], v12 offset:3904
  v_and_b32 v27, v20, v165
  v_fma_f32 v24, v24, v18, v19
  v_fma_f32 v25, v25, v18, v19
  v_mfma_f32_32x32x16_bf16 v[64:79], v[156:159], a[96:99], v[64:79]
  buffer_load_dwordx4 v10, s[8:11], s73 offen offset:2048 lds
  ds_read_b64_tr_b16 a[72:73], v12 offset:3200
  ds_read_b64_tr_b16 a[74:75], v12 offset:3968
  v_fma_f32 v26, v26, v18, v19
  v_fma_f32 v27, v27, v18, v19
  v_cvt_pk_bf16_f32 v164, v24, v25
  v_mfma_f32_32x32x16_bf16 v[80:95], a[100:103], v[156:159], v[80:95]
  ds_read_b64_tr_b16 a[76:77], v13 offset:1536
  ds_read_b64_tr_b16 a[78:79], v13 offset:1920
  v_cvt_pk_bf16_f32 v165, v26, v27
  v_lshlrev_b32 v28, 16, v166
  v_and_b32 v29, v20, v166
  v_mfma_f32_32x32x16_bf16 v[96:111], a[104:107], v[156:159], v[96:111]
  ds_read_b64_tr_b16 a[80:81], v13 offset:1568
  ds_read_b64_tr_b16 a[82:83], v13 offset:1952
  v_lshlrev_b32 v30, 16, v167
  v_and_b32 v31, v20, v167
  v_fma_f32 v28, v28, v18, v19
  v_fma_f32 v29, v29, v18, v19
  s_add_u32 s73, s73, s57
  s_add_u32 m0, s66, 101376
  v_mfma_f32_32x32x16_bf16 v[112:127], a[108:111], v[156:159], v[112:127]
  buffer_load_dwordx4 v8, s[8:11], s73 offen offset:0 lds
  ds_read_b64_tr_b16 a[84:85], v13 offset:1600
  ds_read_b64_tr_b16 a[86:87], v13 offset:1984
  v_fma_f32 v30, v30, v18, v19
  v_fma_f32 v31, v31, v18, v19
  v_cvt_pk_bf16_f32 v166, v28, v29
  v_cvt_pk_bf16_f32 v167, v30, v31
  s_waitcnt lgkmcnt(12)
  v_mfma_f32_32x32x16_bf16 v[32:47], a[112:115], v[160:163], v[32:47]
  ds_read_b64_tr_b16 a[88:89], v12 offset:6144
  ds_read_b64_tr_b16 a[90:91], v12 offset:6912
  v_lshlrev_b32 v24, 16, v168
  v_and_b32 v25, v20, v168
  v_lshlrev_b32 v26, 16, v169
  v_mfma_f32_32x32x16_bf16 v[48:63], a[116:119], v[160:163], v[48:63]
  ds_read_b64_tr_b16 a[92:93], v12 offset:6208
  ds_read_b64_tr_b16 a[94:95], v12 offset:6976
  v_and_b32 v27, v20, v169
  v_fma_f32 v24, v24, v18, v19
  v_fma_f32 v25, v25, v18, v19
  v_mfma_f32_32x32x16_bf16 v[64:79], v[160:163], a[120:123], v[64:79]
  buffer_load_dwordx4 v9, s[8:11], s73 offen offset:1024 lds
  ds_read_b64_tr_b16 a[96:97], v12 offset:6272
  ds_read_b64_tr_b16 a[98:99], v12 offset:7040
  v_fma_f32 v26, v26, v18, v19
  v_fma_f32 v27, v27, v18, v19
  v_cvt_pk_bf16_f32 v168, v24, v25
  v_mfma_f32_32x32x16_bf16 v[80:95], a[124:127], v[160:163], v[80:95]
  ds_read_b64_tr_b16 a[100:101], v13 offset:3072
  ds_read_b64_tr_b16 a[102:103], v13 offset:3456
  v_cvt_pk_bf16_f32 v169, v26, v27
  v_lshlrev_b32 v28, 16, v170
  v_and_b32 v29, v20, v170
  v_mfma_f32_32x32x16_bf16 v[96:111], a[128:131], v[160:163], v[96:111]
  ds_read_b64_tr_b16 a[104:105], v13 offset:3104
  ds_read_b64_tr_b16 a[106:107], v13 offset:3488
  v_lshlrev_b32 v30, 16, v171
  v_and_b32 v31, v20, v171
  v_fma_f32 v28, v28, v18, v19
  v_fma_f32 v29, v29, v18, v19
  v_mfma_f32_32x32x16_bf16 v[112:127], a[132:135], v[160:163], v[112:127]
  buffer_load_dwordx4 v10, s[8:11], s73 offen offset:2048 lds
  ds_read_b64_tr_b16 a[108:109], v13 offset:3136
  ds_read_b64_tr_b16 a[110:111], v13 offset:3520
  v_fma_f32 v30, v30, v18, v19
  v_fma_f32 v31, v31, v18, v19
  v_cvt_pk_bf16_f32 v170, v28, v29
  v_cvt_pk_bf16_f32 v171, v30, v31
  s_waitcnt lgkmcnt(12)
  v_mfma_f32_32x32x16_bf16 v[32:47], a[64:67], v[164:167], v[32:47]
  ds_read_b64_tr_b16 a[112:113], v12 offset:9216
  ds_read_b64_tr_b16 a[114:115], v12 offset:9984
  v_lshlrev_b32 v24, 16, v172
  v_and_b32 v25, v20, v172
  v_lshlrev_b32 v26, 16, v173
  v_mfma_f32_32x32x16_bf16 v[48:63], a[68:71], v[164:167], v[48:63]
  ds_read_b64_tr_b16 a[116:117], v12 offset:9280
  ds_read_b64_tr_b16 a[118:119], v12 offset:10048
  v_and_b32 v27, v20, v173
  v_fma_f32 v24, v24, v18, v19
  v_fma_f32 v25, v25, v18, v19
  s_mul_i32 s92, s67, 5
  s_add_u32 s92, s92, s100
  v_mfma_f32_32x32x16_bf16 v[64:79], v[164:167], a[72:75], v[64:79]
  s_mov_b32 exec_lo, s101
  s_mov_b32 exec_hi, 0
  buffer_load_dword a5, v0, s[8:11], s92 offen
  s_mov_b64 exec, -1
  ds_read_b64_tr_b16 a[120:121], v12 offset:9344
  ds_read_b64_tr_b16 a[122:123], v12 offset:10112
  v_fma_f32 v26, v26, v18, v19
  v_fma_f32 v27, v27, v18, v19
  v_cvt_pk_bf16_f32 v172, v24, v25
  v_mfma_f32_32x32x16_bf16 v[80:95], a[76:79], v[164:167], v[80:95]
  ds_read_b64_tr_b16 a[124:125], v13 offset:4608
  ds_read_b64_tr_b16 a[126:127], v13 offset:4992
  v_cvt_pk_bf16_f32 v173, v26, v27
  v_lshlrev_b32 v28, 16, v174
  v_and_b32 v29, v20, v174
  v_mfma_f32_32x32x16_bf16 v[96:111], a[80:83], v[164:167], v[96:111]
  ds_read_b64_tr_b16 a[128:129], v13 offset:4640
  ds_read_b64_tr_b16 a[130:131], v13 offset:5024
  v_lshlrev_b32 v30, 16, v175
  v_and_b32 v31, v20, v175
  v_fma_f32 v28, v28, v18, v19
  v_fma_f32 v29, v29, v18, v19
  s_mul_i32 s92, s67, 6
  s_add_u32 s92, s92, s100
  v_mfma_f32_32x32x16_bf16 v[112:127], a[84:87], v[164:167], v[112:127]
  s_mov_b32 exec_lo, s101
  s_mov_b32 exec_hi, 0
  buffer_load_dword a6, v0, s[8:11], s92 offen
  s_mov_b64 exec, -1
  ds_read_b64_tr_b16 a[132:133], v13 offset:4672
  ds_read_b64_tr_b16 a[134:135], v13 offset:5056
  v_fma_f32 v30, v30, v18, v19
  v_fma_f32 v31, v31, v18, v19
  v_cvt_pk_bf16_f32 v174, v28, v29
  v_cvt_pk_bf16_f32 v175, v30, v31
  s_waitcnt lgkmcnt(12)
  v_mfma_f32_32x32x16_bf16 v[32:47], a[88:91], v[168:171], v[32:47]
  s_waitcnt vmcnt(8)
  s_barrier
  v_add_u32 v12, 0x00008000, v12
  v_add_u32 v13, 0x00008000, v13
  ds_read_b64_tr_b16 a[64:65], v12 offset:0
  ds_read_b64_tr_b16 a[66:67], v12 offset:768
  v_lshlrev_b32 v24, 16, v176
  v_and_b32 v25, v20, v176
  v_lshlrev_b32 v26, 16, v177
  v_mfma_f32_32x32x16_bf16 v[48:63], a[92:95], v[168:171], v[48:63]
  ds_read_b64_tr_b16 a[68:69], v12 offset:64
  ds_read_b64_tr_b16 a[70:71], v12 offset:832
  v_and_b32 v27, v20, v177
  v_fma_f32 v24, v24, v18, v19
  v_fma_f32 v25, v25, v18, v19
  s_mul_i32 s73, s67, 5
  s_add_u32 s73, s73, s65
  s_add_u32 m0, s66, 0
  v_mfma_f32_32x32x16_bf16 v[64:79], v[168:171], a[96:99], v[64:79]
  buffer_load_dwordx4 v8, s[8:11], s73 offen offset:0 lds
  ds_read_b64_tr_b16 a[72:73], v12 offset:128
  ds_read_b64_tr_b16 a[74:75], v12 offset:896
  v_fma_f32 v26, v26, v18, v19
  v_fma_f32 v27, v27, v18, v19
  v_cvt_pk_bf16_f32 v176, v24, v25
  v_mfma_f32_32x32x16_bf16 v[80:95], a[100:103], v[168:171], v[80:95]
  ds_read_b64_tr_b16 a[76:77], v13 offset:0
  ds_read_b64_tr_b16 a[78:79], v13 offset:384
  v_cvt_pk_bf16_f32 v177, v26, v27
  v_lshlrev_b32 v28, 16, v178
  v_and_b32 v29, v20, v178
  v_mfma_f32_32x32x16_bf16 v[96:111], a[104:107], v[168:171], v[96:111]
  ds_read_b64_tr_b16 a[80:81], v13 offset:32
  ds_read_b64_tr_b16 a[82:83], v13 offset:416
  v_lshlrev_b32 v30, 16, v179
  v_and_b32 v31, v20, v179
  v_fma_f32 v28, v28, v18, v19
  v_fma_f32 v29, v29, v18, v19
  v_mfma_f32_32x32x16_bf16 v[112:127], a[108:111], v[168:171], v[112:127]
  buffer_load_dwordx4 v9, s[8:11], s73 offen offset:1024 lds
  ds_read_b64_tr_b16 a[84:85], v13 offset:64
  ds_read_b64_tr_b16 a[86:87], v13 offset:448
  v_fma_f32 v30, v30, v18, v19
  v_fma_f32 v31, v31, v18, v19
  v_cvt_pk_bf16_f32 v178, v28, v29
  v_cvt_pk_bf16_f32 v179, v30, v31
  s_waitcnt lgkmcnt(12)
  v_mfma_f32_32x32x16_bf16 v[32:47], a[112:115], v[172:175], v[32:47]
  ds_read_b64_tr_b16 a[88:89], v12 offset:3072
  ds_read_b64_tr_b16 a[90:91], v12 offset:3840
  v_lshlrev_b32 v24, 16, v180
  v_and_b32 v25, v20, v180
  v_lshlrev_b32 v26, 16, v181
  v_mfma_f32_32x32x16_bf16 v[48:63], a[116:119], v[172:175], v[48:63]
  ds_read_b64_tr_b16 a[92:93], v12 offset:3136
  ds_read_b64_tr_b16 a[94:95], v12 offset:3904
  v_and_b32 v27, v20, v181
  v_fma_f32 v24, v24, v18, v19
  v_fma_f32 v25, v25, v18, v19
  v_mfma_f32_32x32x16_bf16 v[64:79], v[172:175], a[120:123], v[64:79]
  buffer_load_dwordx4 v10, s[8:11], s73 offen offset:2048 lds
  ds_read_b64_tr_b16 a[96:97], v12 offset:3200
  ds_read_b64_tr_b16 a[98:99], v12 offset:3968
  v_fma_f32 v26, v26, v18, v19
  v_fma_f32 v27, v27, v18, v19
  v_cvt_pk_bf16_f32 v180, v24, v25
  v_mfma_f32_32x32x16_bf16 v[80:95], a[124:127], v[172:175], v[80:95]
  ds_read_b64_tr_b16 a[100:101], v13 offset:1536
  ds_read_b64_tr_b16 a[102:103], v13 offset:1920
  v_cvt_pk_bf16_f32 v181, v26, v27
  v_lshlrev_b32 v28, 16, v182
  v_and_b32 v29, v20, v182
  v_mfma_f32_32x32x16_bf16 v[96:111], a[128:131], v[172:175], v[96:111]
  ds_read_b64_tr_b16 a[104:105], v13 offset:1568
  ds_read_b64_tr_b16 a[106:107], v13 offset:1952
  v_lshlrev_b32 v30, 16, v183
  v_and_b32 v31, v20, v183
  v_fma_f32 v28, v28, v18, v19
  v_fma_f32 v29, v29, v18, v19
  s_add_u32 s73, s73, s57
  s_add_u32 m0, s66, 3072
  v_mfma_f32_32x32x16_bf16 v[112:127], a[132:135], v[172:175], v[112:127]
  buffer_load_dwordx4 v8, s[8:11], s73 offen offset:0 lds
  ds_read_b64_tr_b16 a[108:109], v13 offset:1600
  ds_read_b64_tr_b16 a[110:111], v13 offset:1984
  v_fma_f32 v30, v30, v18, v19
  v_fma_f32 v31, v31, v18, v19
  v_cvt_pk_bf16_f32 v182, v28, v29
  v_cvt_pk_bf16_f32 v183, v30, v31
  s_waitcnt lgkmcnt(12)
  v_mfma_f32_32x32x16_bf16 v[32:47], a[64:67], v[176:179], v[32:47]
  ds_read_b64_tr_b16 a[112:113], v12 offset:6144
  ds_read_b64_tr_b16 a[114:115], v12 offset:6912
  v_lshlrev_b32 v24, 16, v184
  v_and_b32 v25, v20, v184
  v_lshlrev_b32 v26, 16, v185
  v_mfma_f32_32x32x16_bf16 v[48:63], a[68:71], v[176:179], v[48:63]
  ds_read_b64_tr_b16 a[116:117], v12 offset:6208
  ds_read_b64_tr_b16 a[118:119], v12 offset:6976
  v_and_b32 v27, v20, v185
  v_fma_f32 v24, v24, v18, v19
  v_fma_f32 v25, v25, v18, v19
  v_mfma_f32_32x32x16_bf16 v[64:79], v[176:179], a[72:75], v[64:79]
  buffer_load_dwordx4 v9, s[8:11], s73 offen offset:1024 lds
  ds_read_b64_tr_b16 a[120:121], v12 offset:6272
  ds_read_b64_tr_b16 a[122:123], v12 offset:7040
  v_fma_f32 v26, v26, v18, v19
  v_fma_f32 v27, v27, v18, v19
  v_cvt_pk_bf16_f32 v184, v24, v25
  v_mfma_f32_32x32x16_bf16 v[80:95], a[76:79], v[176:179], v[80:95]
  ds_read_b64_tr_b16 a[124:125], v13 offset:3072
  ds_read_b64_tr_b16 a[126:127], v13 offset:3456
  v_cvt_pk_bf16_f32 v185, v26, v27
  v_lshlrev_b32 v28, 16, v186
  v_and_b32 v29, v20, v186
  v_mfma_f32_32x32x16_bf16 v[96:111], a[80:83], v[176:179], v[96:111]
  ds_read_b64_tr_b16 a[128:129], v13 offset:3104
  ds_read_b64_tr_b16 a[130:131], v13 offset:3488
  v_lshlrev_b32 v30, 16, v187
  v_and_b32 v31, v20, v187
  v_fma_f32 v28, v28, v18, v19
  v_fma_f32 v29, v29, v18, v19
  v_mfma_f32_32x32x16_bf16 v[112:127], a[84:87], v[176:179], v[112:127]
  buffer_load_dwordx4 v10, s[8:11], s73 offen offset:2048 lds
  ds_read_b64_tr_b16 a[132:133], v13 offset:3136
  ds_read_b64_tr_b16 a[134:135], v13 offset:3520
  v_fma_f32 v30, v30, v18, v19
  v_fma_f32 v31, v31, v18, v19
  v_cvt_pk_bf16_f32 v186, v28, v29
  v_cvt_pk_bf16_f32 v187, v30, v31
  s_waitcnt lgkmcnt(12)
  v_mfma_f32_32x32x16_bf16 v[32:47], a[88:91], v[180:183], v[32:47]
  ds_read_b64_tr_b16 a[64:65], v12 offset:9216
  ds_read_b64_tr_b16 a[66:67], v12 offset:9984
  v_lshlrev_b32 v24, 16, v188
  v_and_b32 v25, v20, v188
  v_lshlrev_b32 v26, 16, v189
  v_mfma_f32_32x32x16_bf16 v[48:63], a[92:95], v[180:183], v[48:63]
  ds_read_b64_tr_b16 a[68:69], v12 offset:9280
  ds_read_b64_tr_b16 a[70:71], v12 offset:10048
  v_and_b32 v27, v20, v189
  v_fma_f32 v24, v24, v18, v19
  v_fma_f32 v25, v25, v18, v19
  s_mul_i32 s92, s67, 7
  s_add_u32 s92, s92, s100
  v_mfma_f32_32x32x16_bf16 v[64:79], v[180:183], a[96:99], v[64:79]
  s_mov_b32 exec_lo, s101
  s_mov_b32 exec_hi, 0
  buffer_load_dword a7, v0, s[8:11], s92 offen
  s_mov_b64 exec, -1
  ds_read_b64_tr_b16 a[72:73], v12 offset:9344
  ds_read_b64_tr_b16 a[74:75], v12 offset:10112
  v_fma_f32 v26, v26, v18, v19
  v_fma_f32 v27, v27, v18, v19
  v_cvt_pk_bf16_f32 v188, v24, v25
  v_mfma_f32_32x32x16_bf16 v[80:95], a[100:103], v[180:183], v[80:95]
  ds_read_b64_tr_b16 a[76:77], v13 offset:4608
  ds_read_b64_tr_b16 a[78:79], v13 offset:4992
  v_cvt_pk_bf16_f32 v189, v26, v27
  v_lshlrev_b32 v28, 16, v190
  v_and_b32 v29, v20, v190
  v_mfma_f32_32x32x16_bf16 v[96:111], a[104:107], v[180:183], v[96:111]
  ds_read_b64_tr_b16 a[80:81], v13 offset:4640
  ds_read_b64_tr_b16 a[82:83], v13 offset:5024
  v_lshlrev_b32 v30, 16, v191
  v_and_b32 v31, v20, v191
  v_fma_f32 v28, v28, v18, v19
  v_fma_f32 v29, v29, v18, v19
  v_mfma_f32_32x32x16_bf16 v[112:127], a[108:111], v[180:183], v[112:127]
  ds_read_b64_tr_b16 a[84:85], v13 offset:4672
  ds_read_b64_tr_b16 a[86:87], v13 offset:5056
  v_fma_f32 v30, v30, v18, v19
  v_fma_f32 v31, v31, v18, v19
  v_cvt_pk_bf16_f32 v190, v28, v29
  v_cvt_pk_bf16_f32 v191, v30, v31
  s_waitcnt lgkmcnt(12)
  v_mfma_f32_32x32x16_bf16 v[32:47], a[112:115], v[184:187], v[32:47]
  s_waitcnt vmcnt(9)
  s_barrier
  v_add_u32 v12, 0x00008000, v12
  v_add_u32 v13, 0x00008000, v13
  ds_read_b64_tr_b16 a[88:89], v12 offset:0
  ds_read_b64_tr_b16 a[90:91], v12 offset:768
  v_lshlrev_b32 v24, 16, v192
  v_and_b32 v25, v20, v192
  v_lshlrev_b32 v26, 16, v193
  v_mfma_f32_32x32x16_bf16 v[48:63], a[116:119], v[184:187], v[48:63]
  ds_read_b64_tr_b16 a[92:93], v12 offset:64
  ds_read_b64_tr_b16 a[94:95], v12 offset:832
  v_and_b32 v27, v20, v193
  v_fma_f32 v24, v24, v18, v19
  v_fma_f32 v25, v25, v18, v19
  s_mul_i32 s73, s67, 6
  s_add_u32 s73, s73, s65
  s_add_u32 m0, s66, 32768
  v_mfma_f32_32x32x16_bf16 v[64:79], v[184:187], a[120:123], v[64:79]
  buffer_load_dwordx4 v8, s[8:11], s73 offen offset:0 lds
  ds_read_b64_tr_b16 a[96:97], v12 offset:128
  ds_read_b64_tr_b16 a[98:99], v12 offset:896
  v_fma_f32 v26, v26, v18, v19
  v_fma_f32 v27, v27, v18, v19
  v_cvt_pk_bf16_f32 v192, v24, v25
  v_mfma_f32_32x32x16_bf16 v[80:95], a[124:127], v[184:187], v[80:95]
  ds_read_b64_tr_b16 a[100:101], v13 offset:0
  ds_read_b64_tr_b16 a[102:103], v13 offset:384
  v_cvt_pk_bf16_f32 v193, v26, v27
  v_lshlrev_b32 v28, 16, v194
  v_and_b32 v29, v20, v194
  v_mfma_f32_32x32x16_bf16 v[96:111], a[128:131], v[184:187], v[96:111]
  ds_read_b64_tr_b16 a[104:105], v13 offset:32
  ds_read_b64_tr_b16 a[106:107], v13 offset:416
  v_lshlrev_b32 v30, 16, v195
  v_and_b32 v31, v20, v195
  v_fma_f32 v28, v28, v18, v19
  v_fma_f32 v29, v29, v18, v19
  v_mfma_f32_32x32x16_bf16 v[112:127], a[132:135], v[184:187], v[112:127]
  buffer_load_dwordx4 v9, s[8:11], s73 offen offset:1024 lds
  ds_read_b64_tr_b16 a[108:109], v13 offset:64
  ds_read_b64_tr_b16 a[110:111], v13 offset:448
  v_fma_f32 v30, v30, v18, v19
  v_fma_f32 v31, v31, v18, v19
  v_cvt_pk_bf16_f32 v194, v28, v29
  v_cvt_pk_bf16_f32 v195, v30, v31
  s_waitcnt lgkmcnt(12)
  v_mfma_f32_32x32x16_bf16 v[32:47], a[64:67], v[188:191], v[32:47]
  ds_read_b64_tr_b16 a[112:113], v12 offset:3072
  ds_read_b64_tr_b16 a[114:115], v12 offset:3840
  v_lshlrev_b32 v24, 16, v196
  v_and_b32 v25, v20, v196
  v_lshlrev_b32 v26, 16, v197
  v_mfma_f32_32x32x16_bf16 v[48:63], a[68:71], v[188:191], v[48:63]
  ds_read_b64_tr_b16 a[116:117], v12 offset:3136
  ds_read_b64_tr_b16 a[118:119], v12 offset:3904
  v_and_b32 v27, v20, v197
  v_fma_f32 v24, v24, v18, v19
  v_fma_f32 v25, v25, v18, v19
  v_mfma_f32_32x32x16_bf16 v[64:79], v[188:191], a[72:75], v[64:79]
  buffer_load_dwordx4 v10, s[8:11], s73 offen offset:2048 lds
  ds_read_b64_tr_b16 a[120:121], v12 offset:3200
  ds_read_b64_tr_b16 a[122:123], v12 offset:3968
  v_fma_f32 v26, v26, v18, v19
  v_fma_f32 v27, v27, v18, v19
  v_cvt_pk_bf16_f32 v196, v24, v25
  v_mfma_f32_32x32x16_bf16 v[80:95], a[76:79], v[188:191], v[80:95]
  ds_read_b64_tr_b16 a[124:125], v13 offset:1536
  ds_read_b64_tr_b16 a[126:127], v13 offset:1920
  v_cvt_pk_bf16_f32 v197, v26, v27
  v_lshlrev_b32 v28, 16, v198
  v_and_b32 v29, v20, v198
  v_mfma_f32_32x32x16_bf16 v[96:111], a[80:83], v[188:191], v[96:111]
  ds_read_b64_tr_b16 a[128:129], v13 offset:1568
  ds_read_b64_tr_b16 a[130:131], v13 offset:1952
  v_lshlrev_b32 v30, 16, v199
  v_and_b32 v31, v20, v199
  v_fma_f32 v28, v28, v18, v19
  v_fma_f32 v29, v29, v18, v19
  s_add_u32 s73, s73, s57
  s_add_u32 m0, s66, 35840
  v_mfma_f32_32x32x16_bf16 v[112:127], a[84:87], v[188:191], v[112:127]
  buffer_load_dwordx4 v8, s[8:11], s73 offen offset:0 lds
  ds_read_b64_tr_b16 a[132:133], v13 offset:1600
  ds_read_b64_tr_b16 a[134:135], v13 offset:1984
  v_fma_f32 v30, v30, v18, v19
  v_fma_f32 v31, v31, v18, v19
  v_cvt_pk_bf16_f32 v198, v28, v29
  v_cvt_pk_bf16_f32 v199, v30, v31
  s_waitcnt lgkmcnt(12)
  v_mfma_f32_32x32x16_bf16 v[32:47], a[88:91], v[192:195], v[32:47]
  ds_read_b64_tr_b16 a[64:65], v12 offset:6144
  ds_read_b64_tr_b16 a[66:67], v12 offset:6912
  v_lshlrev_b32 v24, 16, v200
  v_and_b32 v25, v20, v200
  v_lshlrev_b32 v26, 16, v201
  v_mfma_f32_32x32x16_bf16 v[48:63], a[92:95], v[192:195], v[48:63]
  ds_read_b64_tr_b16 a[68:69], v12 offset:6208
  ds_read_b64_tr_b16 a[70:71], v12 offset:6976
  v_and_b32 v27, v20, v201
  v_fma_f32 v24, v24, v18, v19
  v_fma_f32 v25, v25, v18, v19
  v_mfma_f32_32x32x16_bf16 v[64:79], v[192:195], a[96:99], v[64:79]
  buffer_load_dwordx4 v9, s[8:11], s73 offen offset:1024 lds
  ds_read_b64_tr_b16 a[72:73], v12 offset:6272
  ds_read_b64_tr_b16 a[74:75], v12 offset:7040
  v_fma_f32 v26, v26, v18, v19
  v_fma_f32 v27, v27, v18, v19
  v_cvt_pk_bf16_f32 v200, v24, v25
  v_mfma_f32_32x32x16_bf16 v[80:95], a[100:103], v[192:195], v[80:95]
  ds_read_b64_tr_b16 a[76:77], v13 offset:3072
  ds_read_b64_tr_b16 a[78:79], v13 offset:3456
  v_cvt_pk_bf16_f32 v201, v26, v27
  v_lshlrev_b32 v28, 16, v202
  v_and_b32 v29, v20, v202
  v_mfma_f32_32x32x16_bf16 v[96:111], a[104:107], v[192:195], v[96:111]
  ds_read_b64_tr_b16 a[80:81], v13 offset:3104
  ds_read_b64_tr_b16 a[82:83], v13 offset:3488
  v_lshlrev_b32 v30, 16, v203
  v_and_b32 v31, v20, v203
  v_fma_f32 v28, v28, v18, v19
  v_fma_f32 v29, v29, v18, v19
  v_mfma_f32_32x32x16_bf16 v[112:127], a[108:111], v[192:195], v[112:127]
  buffer_load_dwordx4 v10, s[8:11], s73 offen offset:2048 lds
  ds_read_b64_tr_b16 a[84:85], v13 offset:3136
  ds_read_b64_tr_b16 a[86:87], v13 offset:3520
  v_fma_f32 v30, v30, v18, v19
  v_fma_f32 v31, v31, v18, v19
  v_cvt_pk_bf16_f32 v202, v28, v29
  v_cvt_pk_bf16_f32 v203, v30, v31
  s_waitcnt lgkmcnt(12)
  v_mfma_f32_32x32x16_bf16 v[32:47], a[112:115], v[196:199], v[32:47]
  ds_read_b64_tr_b16 a[88:89], v12 offset:9216
  ds_read_b64_tr_b16 a[90:91], v12 offset:9984
  v_lshlrev_b32 v24, 16, v204
  v_and_b32 v25, v20, v204
  v_lshlrev_b32 v26, 16, v205
  v_mfma_f32_32x32x16_bf16 v[48:63], a[116:119], v[196:199], v[48:63]
  ds_read_b64_tr_b16 a[92:93], v12 offset:9280
  ds_read_b64_tr_b16 a[94:95], v12 offset:10048
  v_and_b32 v27, v20, v205
  v_fma_f32 v24, v24, v18, v19
  v_fma_f32 v25, v25, v18, v19
  v_mfma_f32_32x32x16_bf16 v[64:79], v[196:199], a[120:123], v[64:79]
  ds_read_b64_tr_b16 a[96:97], v12 offset:9344
  ds_read_b64_tr_b16 a[98:99], v12 offset:10112
  v_fma_f32 v26, v26, v18, v19
  v_fma_f32 v27, v27, v18, v19
  v_cvt_pk_bf16_f32 v204, v24, v25
  v_mfma_f32_32x32x16_bf16 v[80:95], a[124:127], v[196:199], v[80:95]
  ds_read_b64_tr_b16 a[100:101], v13 offset:4608
  ds_read_b64_tr_b16 a[102:103], v13 offset:4992
  v_cvt_pk_bf16_f32 v205, v26, v27
  v_lshlrev_b32 v28, 16, v206
  v_and_b32 v29, v20, v206
  v_mfma_f32_32x32x16_bf16 v[96:111], a[128:131], v[196:199], v[96:111]
  ds_read_b64_tr_b16 a[104:105], v13 offset:4640
  ds_read_b64_tr_b16 a[106:107], v13 offset:5024
  v_lshlrev_b32 v30, 16, v207
  v_and_b32 v31, v20, v207
  v_fma_f32 v28, v28, v18, v19
  v_fma_f32 v29, v29, v18, v19
  v_mfma_f32_32x32x16_bf16 v[112:127], a[132:135], v[196:199], v[112:127]
  ds_read_b64_tr_b16 a[108:109], v13 offset:4672
  ds_read_b64_tr_b16 a[110:111], v13 offset:5056
  v_fma_f32 v30, v30, v18, v19
  v_fma_f32 v31, v31, v18, v19
  v_cvt_pk_bf16_f32 v206, v28, v29
  v_cvt_pk_bf16_f32 v207, v30, v31
  s_waitcnt lgkmcnt(12)
  v_mfma_f32_32x32x16_bf16 v[32:47], a[64:67], v[200:203], v[32:47]
  s_waitcnt vmcnt(7)
  s_barrier
  v_add_u32 v12, 0xfffe8000, v12
  v_add_u32 v13, 0xfffe8000, v13
  ds_read_b64_tr_b16 a[112:113], v12 offset:0
  ds_read_b64_tr_b16 a[114:115], v12 offset:768
  v_lshlrev_b32 v24, 16, v208
  v_and_b32 v25, v20, v208
  v_lshlrev_b32 v26, 16, v209
  v_mfma_f32_32x32x16_bf16 v[48:63], a[68:71], v[200:203], v[48:63]
  ds_read_b64_tr_b16 a[116:117], v12 offset:64
  ds_read_b64_tr_b16 a[118:119], v12 offset:832
  v_and_b32 v27, v20, v209
  v_fma_f32 v24, v24, v18, v19
  v_fma_f32 v25, v25, v18, v19
  s_mul_i32 s73, s67, 7
  s_add_u32 s73, s73, s65
  s_add_u32 m0, s66, 65536
  v_mfma_f32_32x32x16_bf16 v[64:79], v[200:203], a[72:75], v[64:79]
  buffer_load_dwordx4 v8, s[8:11], s73 offen offset:0 lds
  ds_read_b64_tr_b16 a[120:121], v12 offset:128
  ds_read_b64_tr_b16 a[122:123], v12 offset:896
  v_fma_f32 v26, v26, v18, v19
  v_fma_f32 v27, v27, v18, v19
  v_cvt_pk_bf16_f32 v208, v24, v25
  v_mfma_f32_32x32x16_bf16 v[80:95], a[76:79], v[200:203], v[80:95]
  ds_read_b64_tr_b16 a[124:125], v13 offset:0
  ds_read_b64_tr_b16 a[126:127], v13 offset:384
  v_cvt_pk_bf16_f32 v209, v26, v27
  v_lshlrev_b32 v28, 16, v210
  v_and_b32 v29, v20, v210
  v_mfma_f32_32x32x16_bf16 v[96:111], a[80:83], v[200:203], v[96:111]
  ds_read_b64_tr_b16 a[128:129], v13 offset:32
  ds_read_b64_tr_b16 a[130:131], v13 offset:416
  v_lshlrev_b32 v30, 16, v211
  v_and_b32 v31, v20, v211
  v_fma_f32 v28, v28, v18, v19
  v_fma_f32 v29, v29, v18, v19
  v_mfma_f32_32x32x16_bf16 v[112:127], a[84:87], v[200:203], v[112:127]
  buffer_load_dwordx4 v9, s[8:11], s73 offen offset:1024 lds
  ds_read_b64_tr_b16 a[132:133], v13 offset:64
  ds_read_b64_tr_b16 a[134:135], v13 offset:448
  v_fma_f32 v30, v30, v18, v19
  v_fma_f32 v31, v31, v18, v19
  v_cvt_pk_bf16_f32 v210, v28, v29
  v_cvt_pk_bf16_f32 v211, v30, v31
  s_waitcnt lgkmcnt(12)
  v_mfma_f32_32x32x16_bf16 v[32:47], a[88:91], v[204:207], v[32:47]
  ds_read_b64_tr_b16 a[64:65], v12 offset:3072
  ds_read_b64_tr_b16 a[66:67], v12 offset:3840
  v_lshlrev_b32 v24, 16, v212
  v_and_b32 v25, v20, v212
  v_lshlrev_b32 v26, 16, v213
  v_mfma_f32_32x32x16_bf16 v[48:63], a[92:95], v[204:207], v[48:63]
  ds_read_b64_tr_b16 a[68:69], v12 offset:3136
  ds_read_b64_tr_b16 a[70:71], v12 offset:3904
  v_and_b32 v27, v20, v213
  v_fma_f32 v24, v24, v18, v19
  v_fma_f32 v25, v25, v18, v19
  v_mfma_f32_32x32x16_bf16 v[64:79], v[204:207], a[96:99], v[64:79]
  buffer_load_dwordx4 v10, s[8:11], s73 offen offset:2048 lds
  ds_read_b64_tr_b16 a[72:73], v12 offset:3200
  ds_read_b64_tr_b16 a[74:75], v12 offset:3968
  v_fma_f32 v26, v26, v18, v19
  v_fma_f32 v27, v27, v18, v19
  v_cvt_pk_bf16_f32 v212, v24, v25
  v_mfma_f32_32x32x16_bf16 v[80:95], a[100:103], v[204:207], v[80:95]
  ds_read_b64_tr_b16 a[76:77], v13 offset:1536
  ds_read_b64_tr_b16 a[78:79], v13 offset:1920
  v_cvt_pk_bf16_f32 v213, v26, v27
  v_lshlrev_b32 v28, 16, v214
  v_and_b32 v29, v20, v214
  v_mfma_f32_32x32x16_bf16 v[96:111], a[104:107], v[204:207], v[96:111]
  ds_read_b64_tr_b16 a[80:81], v13 offset:1568
  ds_read_b64_tr_b16 a[82:83], v13 offset:1952
  v_lshlrev_b32 v30, 16, v215
  v_and_b32 v31, v20, v215
  v_fma_f32 v28, v28, v18, v19
  v_fma_f32 v29, v29, v18, v19
  s_add_u32 s73, s73, s57
  s_add_u32 m0, s66, 68608
  v_mfma_f32_32x32x16_bf16 v[112:127], a[108:111], v[204:207], v[112:127]
  buffer_load_dwordx4 v8, s[8:11], s73 offen offset:0 lds
  ds_read_b64_tr_b16 a[84:85], v13 offset:1600
  ds_read_b64_tr_b16 a[86:87], v13 offset:1984
  v_fma_f32 v30, v30, v18, v19
  v_fma_f32 v31, v31, v18, v19
  v_cvt_pk_bf16_f32 v214, v28, v29
  v_cvt_pk_bf16_f32 v215, v30, v31
  s_waitcnt lgkmcnt(12)
  v_mfma_f32_32x32x16_bf16 v[32:47], a[112:115], v[208:211], v[32:47]
  ds_read_b64_tr_b16 a[88:89], v12 offset:6144
  ds_read_b64_tr_b16 a[90:91], v12 offset:6912
  v_lshlrev_b32 v24, 16, v216
  v_and_b32 v25, v20, v216
  v_lshlrev_b32 v26, 16, v217
  v_mfma_f32_32x32x16_bf16 v[48:63], a[116:119], v[208:211], v[48:63]
  ds_read_b64_tr_b16 a[92:93], v12 offset:6208
  ds_read_b64_tr_b16 a[94:95], v12 offset:6976
  v_and_b32 v27, v20, v217
  v_fma_f32 v24, v24, v18, v19
  v_fma_f32 v25, v25, v18, v19
  v_mfma_f32_32x32x16_bf16 v[64:79], v[208:211], a[120:123], v[64:79]
  buffer_load_dwordx4 v9, s[8:11], s73 offen offset:1024 lds
  ds_read_b64_tr_b16 a[96:97], v12 offset:6272
  ds_read_b64_tr_b16 a[98:99], v12 offset:7040
  v_fma_f32 v26, v26, v18, v19
  v_fma_f32 v27, v27, v18, v19
  v_cvt_pk_bf16_f32 v216, v24, v25
  v_mfma_f32_32x32x16_bf16 v[80:95], a[124:127], v[208:211], v[80:95]
  ds_read_b64_tr_b16 a[100:101], v13 offset:3072
  ds_read_b64_tr_b16 a[102:103], v13 offset:3456
  v_cvt_pk_bf16_f32 v217, v26, v27
  v_lshlrev_b32 v28, 16, v218
  v_and_b32 v29, v20, v218
  v_mfma_f32_32x32x16_bf16 v[96:111], a[128:131], v[208:211], v[96:111]
  ds_read_b64_tr_b16 a[104:105], v13 offset:3104
  ds_read_b64_tr_b16 a[106:107], v13 offset:3488
  v_lshlrev_b32 v30, 16, v219
  v_and_b32 v31, v20, v219
  v_fma_f32 v28, v28, v18, v19
  v_fma_f32 v29, v29, v18, v19
  v_mfma_f32_32x32x16_bf16 v[112:127], a[132:135], v[208:211], v[112:127]
  buffer_load_dwordx4 v10, s[8:11], s73 offen offset:2048 lds
  ds_read_b64_tr_b16 a[108:109], v13 offset:3136
  ds_read_b64_tr_b16 a[110:111], v13 offset:3520
  v_fma_f32 v30, v30, v18, v19
  v_fma_f32 v31, v31, v18, v19
  v_cvt_pk_bf16_f32 v218, v28, v29
  v_cvt_pk_bf16_f32 v219, v30, v31
  s_waitcnt lgkmcnt(12)
  v_mfma_f32_32x32x16_bf16 v[32:47], a[64:67], v[212:215], v[32:47]
  ds_read_b64_tr_b16 a[112:113], v12 offset:9216
  ds_read_b64_tr_b16 a[114:115], v12 offset:9984
  v_lshlrev_b32 v24, 16, v220
  v_and_b32 v25, v20, v220
  v_lshlrev_b32 v26, 16, v221
  v_mfma_f32_32x32x16_bf16 v[48:63], a[68:71], v[212:215], v[48:63]
  ds_read_b64_tr_b16 a[116:117], v12 offset:9280
  ds_read_b64_tr_b16 a[118:119], v12 offset:10048
  v_and_b32 v27, v20, v221
  v_fma_f32 v24, v24, v18, v19
  v_fma_f32 v25, v25, v18, v19
  v_mfma_f32_32x32x16_bf16 v[64:79], v[212:215], a[72:75], v[64:79]
  ds_read_b64_tr_b16 a[120:121], v12 offset:9344
  ds_read_b64_tr_b16 a[122:123], v12 offset:10112
  v_fma_f32 v26, v26, v18, v19
  v_fma_f32 v27, v27, v18, v19
  v_cvt_pk_bf16_f32 v220, v24, v25
  v_mfma_f32_32x32x16_bf16 v[80:95], a[76:79], v[212:215], v[80:95]
  ds_read_b64_tr_b16 a[124:125], v13 offset:4608
  ds_read_b64_tr_b16 a[126:127], v13 offset:4992
  v_cvt_pk_bf16_f32 v221, v26, v27
  v_lshlrev_b32 v28, 16, v222
  v_and_b32 v29, v20, v222
  v_mfma_f32_32x32x16_bf16 v[96:111], a[80:83], v[212:215], v[96:111]
  ds_read_b64_tr_b16 a[128:129], v13 offset:4640
  ds_read_b64_tr_b16 a[130:131], v13 offset:5024
  v_lshlrev_b32 v30, 16, v223
  v_and_b32 v31, v20, v223
  v_fma_f32 v28, v28, v18, v19
  v_fma_f32 v29, v29, v18, v19
  v_mfma_f32_32x32x16_bf16 v[112:127], a[84:87], v[212:215], v[112:127]
  ds_read_b64_tr_b16 a[132:133], v13 offset:4672
  ds_read_b64_tr_b16 a[134:135], v13 offset:5056
  v_fma_f32 v30, v30, v18, v19
  v_fma_f32 v31, v31, v18, v19
  v_cvt_pk_bf16_f32 v222, v28, v29
  v_cvt_pk_bf16_f32 v223, v30, v31
  s_waitcnt lgkmcnt(12)
  v_mfma_f32_32x32x16_bf16 v[32:47], a[88:91], v[216:219], v[32:47]
  s_waitcnt vmcnt(6)
  s_barrier
  v_add_u32 v12, 0x00008000, v12
  v_add_u32 v13, 0x00008000, v13
  ds_read_b64_tr_b16 a[64:65], v12 offset:0
  ds_read_b64_tr_b16 a[66:67], v12 offset:768
  v_lshlrev_b32 v24, 16, v224
  v_and_b32 v25, v20, v224
  v_lshlrev_b32 v26, 16, v225
  v_mfma_f32_32x32x16_bf16 v[48:63], a[92:95], v[216:219], v[48:63]
  ds_read_b64_tr_b16 a[68:69], v12 offset:64
  ds_read_b64_tr_b16 a[70:71], v12 offset:832
  v_and_b32 v27, v20, v225
  v_fma_f32 v24, v24, v18, v19
  v_fma_f32 v25, v25, v18, v19
  s_add_u32 s74, s68, 0
  s_add_u32 m0, s69, 98304
  v_mfma_f32_32x32x16_bf16 v[64:79], v[216:219], a[96:99], v[64:79]
  buffer_load_dwordx4 v11, s[12:15], s74 offen offset:0 lds
  ds_read_b64_tr_b16 a[72:73], v12 offset:128
  ds_read_b64_tr_b16 a[74:75], v12 offset:896
  v_fma_f32 v26, v26, v18, v19
  v_fma_f32 v27, v27, v18, v19
  v_cvt_pk_bf16_f32 v224, v24, v25
  v_mfma_f32_32x32x16_bf16 v[80:95], a[100:103], v[216:219], v[80:95]
  ds_read_b64_tr_b16 a[76:77], v13 offset:0
  ds_read_b64_tr_b16 a[78:79], v13 offset:384
  v_cvt_pk_bf16_f32 v225, v26, v27
  v_lshlrev_b32 v28, 16, v226
  v_and_b32 v29, v20, v226
  v_mfma_f32_32x32x16_bf16 v[96:111], a[104:107], v[216:219], v[96:111]
  ds_read_b64_tr_b16 a[80:81], v13 offset:32
  ds_read_b64_tr_b16 a[82:83], v13 offset:416
  v_lshlrev_b32 v30, 16, v227
  v_and_b32 v31, v20, v227
  v_fma_f32 v28, v28, v18, v19
  v_fma_f32 v29, v29, v18, v19
  v_mfma_f32_32x32x16_bf16 v[112:127], a[108:111], v[216:219], v[112:127]
  buffer_load_dwordx4 v4, s[12:15], s74 offen offset:1024 lds
  ds_read_b64_tr_b16 a[84:85], v13 offset:64
  ds_read_b64_tr_b16 a[86:87], v13 offset:448
  v_fma_f32 v30, v30, v18, v19
  v_fma_f32 v31, v31, v18, v19
  v_cvt_pk_bf16_f32 v226, v28, v29
  v_cvt_pk_bf16_f32 v227, v30, v31
  s_waitcnt lgkmcnt(12)
  v_mfma_f32_32x32x16_bf16 v[32:47], a[112:115], v[220:223], v[32:47]
  ds_read_b64_tr_b16 a[88:89], v12 offset:3072
  ds_read_b64_tr_b16 a[90:91], v12 offset:3840
  v_lshlrev_b32 v24, 16, v228
  v_and_b32 v25, v20, v228
  v_lshlrev_b32 v26, 16, v229
  v_mfma_f32_32x32x16_bf16 v[48:63], a[116:119], v[220:223], v[48:63]
  ds_read_b64_tr_b16 a[92:93], v12 offset:3136
  ds_read_b64_tr_b16 a[94:95], v12 offset:3904
  v_and_b32 v27, v20, v229
  v_fma_f32 v24, v24, v18, v19
  v_fma_f32 v25, v25, v18, v19
  v_mfma_f32_32x32x16_bf16 v[64:79], v[220:223], a[120:123], v[64:79]
  buffer_load_dwordx4 v5, s[12:15], s74 offen offset:2048 lds
  ds_read_b64_tr_b16 a[96:97], v12 offset:3200
  ds_read_b64_tr_b16 a[98:99], v12 offset:3968
  v_fma_f32 v26, v26, v18, v19
  v_fma_f32 v27, v27, v18, v19
  v_cvt_pk_bf16_f32 v228, v24, v25
  v_mfma_f32_32x32x16_bf16 v[80:95], a[124:127], v[220:223], v[80:95]
  ds_read_b64_tr_b16 a[100:101], v13 offset:1536
  ds_read_b64_tr_b16 a[102:103], v13 offset:1920
  v_cvt_pk_bf16_f32 v229, v26, v27
  v_lshlrev_b32 v28, 16, v230
  v_and_b32 v29, v20, v230
  v_mfma_f32_32x32x16_bf16 v[96:111], a[128:131], v[220:223], v[96:111]
  ds_read_b64_tr_b16 a[104:105], v13 offset:1568
  ds_read_b64_tr_b16 a[106:107], v13 offset:1952
  v_lshlrev_b32 v30, 16, v231
  v_and_b32 v31, v20, v231
  v_fma_f32 v28, v28, v18, v19
  v_fma_f32 v29, v29, v18, v19
  v_mfma_f32_32x32x16_bf16 v[112:127], a[132:135], v[220:223], v[112:127]
  buffer_load_dwordx4 v6, s[12:15], s74 offen offset:3072 lds
  ds_read_b64_tr_b16 a[108:109], v13 offset:1600
  ds_read_b64_tr_b16 a[110:111], v13 offset:1984
  v_fma_f32 v30, v30, v18, v19
  v_fma_f32 v31, v31, v18, v19
  v_cvt_pk_bf16_f32 v230, v28, v29
  v_cvt_pk_bf16_f32 v231, v30, v31
  s_waitcnt lgkmcnt(12)
  v_mfma_f32_32x32x16_bf16 v[32:47], a[64:67], v[224:227], v[32:47]
  ds_read_b64_tr_b16 a[112:113], v12 offset:6144
  ds_read_b64_tr_b16 a[114:115], v12 offset:6912
  v_lshlrev_b32 v24, 16, v232
  v_and_b32 v25, v20, v232
  v_lshlrev_b32 v26, 16, v233
  v_mfma_f32_32x32x16_bf16 v[48:63], a[68:71], v[224:227], v[48:63]
  ds_read_b64_tr_b16 a[116:117], v12 offset:6208
  ds_read_b64_tr_b16 a[118:119], v12 offset:6976
  v_and_b32 v27, v20, v233
  v_fma_f32 v24, v24, v18, v19
  v_fma_f32 v25, v25, v18, v19
  s_add_u32 s74, s68, 114688
  s_add_u32 m0, s69, 102400
  v_mfma_f32_32x32x16_bf16 v[64:79], v[224:227], a[72:75], v[64:79]
  buffer_load_dwordx4 v11, s[12:15], s74 offen offset:0 lds
  ds_read_b64_tr_b16 a[120:121], v12 offset:6272
  ds_read_b64_tr_b16 a[122:123], v12 offset:7040
  v_fma_f32 v26, v26, v18, v19
  v_fma_f32 v27, v27, v18, v19
  v_cvt_pk_bf16_f32 v232, v24, v25
  v_mfma_f32_32x32x16_bf16 v[80:95], a[76:79], v[224:227], v[80:95]
  ds_read_b64_tr_b16 a[124:125], v13 offset:3072
  ds_read_b64_tr_b16 a[126:127], v13 offset:3456
  v_cvt_pk_bf16_f32 v233, v26, v27
  v_lshlrev_b32 v28, 16, v234
  v_and_b32 v29, v20, v234
  v_mfma_f32_32x32x16_bf16 v[96:111], a[80:83], v[224:227], v[96:111]
  ds_read_b64_tr_b16 a[128:129], v13 offset:3104
  ds_read_b64_tr_b16 a[130:131], v13 offset:3488
  v_lshlrev_b32 v30, 16, v235
  v_and_b32 v31, v20, v235
  v_fma_f32 v28, v28, v18, v19
  v_fma_f32 v29, v29, v18, v19
  v_mfma_f32_32x32x16_bf16 v[112:127], a[84:87], v[224:227], v[112:127]
  buffer_load_dwordx4 v4, s[12:15], s74 offen offset:1024 lds
  ds_read_b64_tr_b16 a[132:133], v13 offset:3136
  ds_read_b64_tr_b16 a[134:135], v13 offset:3520
  v_fma_f32 v30, v30, v18, v19
  v_fma_f32 v31, v31, v18, v19
  v_cvt_pk_bf16_f32 v234, v28, v29
  v_cvt_pk_bf16_f32 v235, v30, v31
  s_waitcnt lgkmcnt(12)
  v_mfma_f32_32x32x16_bf16 v[32:47], a[88:91], v[228:231], v[32:47]
  ds_read_b64_tr_b16 a[64:65], v12 offset:9216
  ds_read_b64_tr_b16 a[66:67], v12 offset:9984
  v_lshlrev_b32 v24, 16, v236
  v_and_b32 v25, v20, v236
  v_lshlrev_b32 v26, 16, v237
  v_mfma_f32_32x32x16_bf16 v[48:63], a[92:95], v[228:231], v[48:63]
  ds_read_b64_tr_b16 a[68:69], v12 offset:9280
  ds_read_b64_tr_b16 a[70:71], v12 offset:10048
  v_and_b32 v27, v20, v237
  v_fma_f32 v24, v24, v18, v19
  v_fma_f32 v25, v25, v18, v19
  v_mfma_f32_32x32x16_bf16 v[64:79], v[228:231], a[96:99], v[64:79]
  buffer_load_dwordx4 v5, s[12:15], s74 offen offset:2048 lds
  ds_read_b64_tr_b16 a[72:73], v12 offset:9344
  ds_read_b64_tr_b16 a[74:75], v12 offset:10112
  v_fma_f32 v26, v26, v18, v19
  v_fma_f32 v27, v27, v18, v19
  v_cvt_pk_bf16_f32 v236, v24, v25
  v_mfma_f32_32x32x16_bf16 v[80:95], a[100:103], v[228:231], v[80:95]
  ds_read_b64_tr_b16 a[76:77], v13 offset:4608
  ds_read_b64_tr_b16 a[78:79], v13 offset:4992
  v_cvt_pk_bf16_f32 v237, v26, v27
  v_lshlrev_b32 v28, 16, v238
  v_and_b32 v29, v20, v238
  v_mfma_f32_32x32x16_bf16 v[96:111], a[104:107], v[228:231], v[96:111]
  ds_read_b64_tr_b16 a[80:81], v13 offset:4640
  ds_read_b64_tr_b16 a[82:83], v13 offset:5024
  v_lshlrev_b32 v30, 16, v239
  v_and_b32 v31, v20, v239
  v_fma_f32 v28, v28, v18, v19
  v_fma_f32 v29, v29, v18, v19
  v_mfma_f32_32x32x16_bf16 v[112:127], a[108:111], v[228:231], v[112:127]
  buffer_load_dwordx4 v6, s[12:15], s74 offen offset:3072 lds
  ds_read_b64_tr_b16 a[84:85], v13 offset:4672
  ds_read_b64_tr_b16 a[86:87], v13 offset:5056
  v_fma_f32 v30, v30, v18, v19
  v_fma_f32 v31, v31, v18, v19
  v_cvt_pk_bf16_f32 v238, v28, v29
  v_cvt_pk_bf16_f32 v239, v30, v31
  s_waitcnt lgkmcnt(12)
  v_mfma_f32_32x32x16_bf16 v[32:47], a[112:115], v[232:235], v[32:47]
  s_waitcnt vmcnt(8)
  s_barrier
  v_add_u32 v12, 0x00008000, v12
  v_add_u32 v13, 0x00008000, v13
  ds_read_b64_tr_b16 a[88:89], v12 offset:0
  ds_read_b64_tr_b16 a[90:91], v12 offset:768
  v_lshlrev_b32 v24, 16, v240
  v_and_b32 v25, v20, v240
  v_lshlrev_b32 v26, 16, v241
  v_mfma_f32_32x32x16_bf16 v[48:63], a[116:119], v[232:235], v[48:63]
  ds_read_b64_tr_b16 a[92:93], v12 offset:64
  ds_read_b64_tr_b16 a[94:95], v12 offset:832
  v_and_b32 v27, v20, v241
  v_fma_f32 v24, v24, v18, v19
  v_fma_f32 v25, v25, v18, v19
  s_add_u32 s74, s68, 458752
  s_add_u32 m0, s69, 0
  v_mfma_f32_32x32x16_bf16 v[64:79], v[232:235], a[120:123], v[64:79]
  buffer_load_dwordx4 v11, s[12:15], s74 offen offset:0 lds
  ds_read_b64_tr_b16 a[96:97], v12 offset:128
  ds_read_b64_tr_b16 a[98:99], v12 offset:896
  v_fma_f32 v26, v26, v18, v19
  v_fma_f32 v27, v27, v18, v19
  v_cvt_pk_bf16_f32 v240, v24, v25
  v_mfma_f32_32x32x16_bf16 v[80:95], a[124:127], v[232:235], v[80:95]
  ds_read_b64_tr_b16 a[100:101], v13 offset:0
  ds_read_b64_tr_b16 a[102:103], v13 offset:384
  v_cvt_pk_bf16_f32 v241, v26, v27
  v_lshlrev_b32 v28, 16, v242
  v_and_b32 v29, v20, v242
  v_mfma_f32_32x32x16_bf16 v[96:111], a[128:131], v[232:235], v[96:111]
  ds_read_b64_tr_b16 a[104:105], v13 offset:32
  ds_read_b64_tr_b16 a[106:107], v13 offset:416
  v_lshlrev_b32 v30, 16, v243
  v_and_b32 v31, v20, v243
  v_fma_f32 v28, v28, v18, v19
  v_fma_f32 v29, v29, v18, v19
  v_mfma_f32_32x32x16_bf16 v[112:127], a[132:135], v[232:235], v[112:127]
  buffer_load_dwordx4 v4, s[12:15], s74 offen offset:1024 lds
  ds_read_b64_tr_b16 a[108:109], v13 offset:64
  ds_read_b64_tr_b16 a[110:111], v13 offset:448
  v_fma_f32 v30, v30, v18, v19
  v_fma_f32 v31, v31, v18, v19
  v_cvt_pk_bf16_f32 v242, v28, v29
  v_cvt_pk_bf16_f32 v243, v30, v31
  s_waitcnt lgkmcnt(12)
  v_mfma_f32_32x32x16_bf16 v[32:47], a[64:67], v[236:239], v[32:47]
  ds_read_b64_tr_b16 a[112:113], v12 offset:3072
  ds_read_b64_tr_b16 a[114:115], v12 offset:3840
  v_lshlrev_b32 v24, 16, v244
  v_and_b32 v25, v20, v244
  v_lshlrev_b32 v26, 16, v245
  v_mfma_f32_32x32x16_bf16 v[48:63], a[68:71], v[236:239], v[48:63]
  ds_read_b64_tr_b16 a[116:117], v12 offset:3136
  ds_read_b64_tr_b16 a[118:119], v12 offset:3904
  v_and_b32 v27, v20, v245
  v_fma_f32 v24, v24, v18, v19
  v_fma_f32 v25, v25, v18, v19
  v_mfma_f32_32x32x16_bf16 v[64:79], v[236:239], a[72:75], v[64:79]
  buffer_load_dwordx4 v5, s[12:15], s74 offen offset:2048 lds
  ds_read_b64_tr_b16 a[120:121], v12 offset:3200
  ds_read_b64_tr_b16 a[122:123], v12 offset:3968
  v_fma_f32 v26, v26, v18, v19
  v_fma_f32 v27, v27, v18, v19
  v_cvt_pk_bf16_f32 v244, v24, v25
  v_mfma_f32_32x32x16_bf16 v[80:95], a[76:79], v[236:239], v[80:95]
  ds_read_b64_tr_b16 a[124:125], v13 offset:1536
  ds_read_b64_tr_b16 a[126:127], v13 offset:1920
  v_cvt_pk_bf16_f32 v245, v26, v27
  v_lshlrev_b32 v28, 16, v246
  v_and_b32 v29, v20, v246
  v_mfma_f32_32x32x16_bf16 v[96:111], a[80:83], v[236:239], v[96:111]
  ds_read_b64_tr_b16 a[128:129], v13 offset:1568
  ds_read_b64_tr_b16 a[130:131], v13 offset:1952
  v_lshlrev_b32 v30, 16, v247
  v_and_b32 v31, v20, v247
  v_fma_f32 v28, v28, v18, v19
  v_fma_f32 v29, v29, v18, v19
  v_mfma_f32_32x32x16_bf16 v[112:127], a[84:87], v[236:239], v[112:127]
  buffer_load_dwordx4 v6, s[12:15], s74 offen offset:3072 lds
  ds_read_b64_tr_b16 a[132:133], v13 offset:1600
  ds_read_b64_tr_b16 a[134:135], v13 offset:1984
  v_fma_f32 v30, v30, v18, v19
  v_fma_f32 v31, v31, v18, v19
  v_cvt_pk_bf16_f32 v246, v28, v29
  v_cvt_pk_bf16_f32 v247, v30, v31
  s_waitcnt lgkmcnt(12)
  v_mfma_f32_32x32x16_bf16 v[32:47], a[88:91], v[240:243], v[32:47]
  ds_read_b64_tr_b16 a[64:65], v12 offset:6144
  ds_read_b64_tr_b16 a[66:67], v12 offset:6912
  v_lshlrev_b32 v24, 16, v248
  v_and_b32 v25, v20, v248
  v_lshlrev_b32 v26, 16, v249
  v_mfma_f32_32x32x16_bf16 v[48:63], a[92:95], v[240:243], v[48:63]
  ds_read_b64_tr_b16 a[68:69], v12 offset:6208
  ds_read_b64_tr_b16 a[70:71], v12 offset:6976
  v_and_b32 v27, v20, v249
  v_fma_f32 v24, v24, v18, v19
  v_fma_f32 v25, v25, v18, v19
  s_add_u32 s74, s68, 573440
  s_add_u32 m0, s69, 4096
  v_mfma_f32_32x32x16_bf16 v[64:79], v[240:243], a[96:99], v[64:79]
  buffer_load_dwordx4 v11, s[12:15], s74 offen offset:0 lds
  ds_read_b64_tr_b16 a[72:73], v12 offset:6272
  ds_read_b64_tr_b16 a[74:75], v12 offset:7040
  v_fma_f32 v26, v26, v18, v19
  v_fma_f32 v27, v27, v18, v19
  v_cvt_pk_bf16_f32 v248, v24, v25
  v_mfma_f32_32x32x16_bf16 v[80:95], a[100:103], v[240:243], v[80:95]
  ds_read_b64_tr_b16 a[76:77], v13 offset:3072
  ds_read_b64_tr_b16 a[78:79], v13 offset:3456
  v_cvt_pk_bf16_f32 v249, v26, v27
  v_lshlrev_b32 v28, 16, v250
  v_and_b32 v29, v20, v250
  v_mfma_f32_32x32x16_bf16 v[96:111], a[104:107], v[240:243], v[96:111]
  ds_read_b64_tr_b16 a[80:81], v13 offset:3104
  ds_read_b64_tr_b16 a[82:83], v13 offset:3488
  v_lshlrev_b32 v30, 16, v251
  v_and_b32 v31, v20, v251
  v_fma_f32 v28, v28, v18, v19
  v_fma_f32 v29, v29, v18, v19
  v_mfma_f32_32x32x16_bf16 v[112:127], a[108:111], v[240:243], v[112:127]
  buffer_load_dwordx4 v4, s[12:15], s74 offen offset:1024 lds
  ds_read_b64_tr_b16 a[84:85], v13 offset:3136
  ds_read_b64_tr_b16 a[86:87], v13 offset:3520
  v_fma_f32 v30, v30, v18, v19
  v_fma_f32 v31, v31, v18, v19
  v_cvt_pk_bf16_f32 v250, v28, v29
  v_cvt_pk_bf16_f32 v251, v30, v31
  s_waitcnt lgkmcnt(12)
  v_mfma_f32_32x32x16_bf16 v[32:47], a[112:115], v[244:247], v[32:47]
  ds_read_b64_tr_b16 a[88:89], v12 offset:9216
  ds_read_b64_tr_b16 a[90:91], v12 offset:9984
  v_lshlrev_b32 v24, 16, v252
  v_and_b32 v25, v20, v252
  v_lshlrev_b32 v26, 16, v253
  v_mfma_f32_32x32x16_bf16 v[48:63], a[116:119], v[244:247], v[48:63]
  ds_read_b64_tr_b16 a[92:93], v12 offset:9280
  ds_read_b64_tr_b16 a[94:95], v12 offset:10048
  v_and_b32 v27, v20, v253
  v_fma_f32 v24, v24, v18, v19
  v_fma_f32 v25, v25, v18, v19
  v_mfma_f32_32x32x16_bf16 v[64:79], v[244:247], a[120:123], v[64:79]
  buffer_load_dwordx4 v5, s[12:15], s74 offen offset:2048 lds
  ds_read_b64_tr_b16 a[96:97], v12 offset:9344
  ds_read_b64_tr_b16 a[98:99], v12 offset:10112
  v_fma_f32 v26, v26, v18, v19
  v_fma_f32 v27, v27, v18, v19
  v_cvt_pk_bf16_f32 v252, v24, v25
  v_mfma_f32_32x32x16_bf16 v[80:95], a[124:127], v[244:247], v[80:95]
  ds_read_b64_tr_b16 a[100:101], v13 offset:4608
  ds_read_b64_tr_b16 a[102:103], v13 offset:4992
  v_cvt_pk_bf16_f32 v253, v26, v27
  v_lshlrev_b32 v28, 16, v254
  v_and_b32 v29, v20, v254
  v_mfma_f32_32x32x16_bf16 v[96:111], a[128:131], v[244:247], v[96:111]
  ds_read_b64_tr_b16 a[104:105], v13 offset:4640
  ds_read_b64_tr_b16 a[106:107], v13 offset:5024
  v_lshlrev_b32 v30, 16, v255
  v_and_b32 v31, v20, v255
  v_fma_f32 v28, v28, v18, v19
  v_fma_f32 v29, v29, v18, v19
  v_mfma_f32_32x32x16_bf16 v[112:127], a[132:135], v[244:247], v[112:127]
  buffer_load_dwordx4 v6, s[12:15], s74 offen offset:3072 lds
  ds_read_b64_tr_b16 a[108:109], v13 offset:4672
  ds_read_b64_tr_b16 a[110:111], v13 offset:5056
  v_fma_f32 v30, v30, v18, v19
  v_fma_f32 v31, v31, v18, v19
  v_cvt_pk_bf16_f32 v254, v28, v29
  v_cvt_pk_bf16_f32 v255, v30, v31
  s_waitcnt lgkmcnt(12)
  v_mfma_f32_32x32x16_bf16 v[32:47], a[64:67], v[248:251], v[32:47]
  s_waitcnt vmcnt(8)
  s_barrier
  ds_read_b64_tr_b16 a[112:113], v14 offset:0
  ds_read_b64_tr_b16 a[114:115], v14 offset:512
  v_mfma_f32_32x32x16_bf16 v[48:63], a[68:71], v[248:251], v[48:63]
  ds_read_b64_tr_b16 a[116:117], v15 offset:0
  ds_read_b64_tr_b16 a[118:119], v15 offset:512
  s_add_u32 s74, s68, 917504
  s_add_u32 m0, s69, 32768
  v_mfma_f32_32x32x16_bf16 v[64:79], v[248:251], a[72:75], v[64:79]
  buffer_load_dwordx4 v11, s[12:15], s74 offen offset:0 lds
  ds_read_b64_tr_b16 a[120:121], v16 offset:0
  ds_read_b64_tr_b16 a[122:123], v16 offset:512
  v_mfma_f32_32x32x16_bf16 v[80:95], a[76:79], v[248:251], v[80:95]
  ds_read_b64_tr_b16 a[124:125], v17 offset:0
  ds_read_b64_tr_b16 a[126:127], v17 offset:512
  v_mfma_f32_32x32x16_bf16 v[96:111], a[80:83], v[248:251], v[96:111]
  v_mfma_f32_32x32x16_bf16 v[112:127], a[84:87], v[248:251], v[112:127]
  buffer_load_dwordx4 v4, s[12:15], s74 offen offset:1024 lds
  s_waitcnt lgkmcnt(8)
  v_mfma_f32_32x32x16_bf16 v[32:47], a[88:91], v[252:255], v[32:47]
  ds_read_b64_tr_b16 a[64:65], v14 offset:2048
  ds_read_b64_tr_b16 a[66:67], v14 offset:2560
  v_mfma_f32_32x32x16_bf16 v[48:63], a[92:95], v[252:255], v[48:63]
  ds_read_b64_tr_b16 a[68:69], v15 offset:2048
  ds_read_b64_tr_b16 a[70:71], v15 offset:2560
  v_mfma_f32_32x32x16_bf16 v[64:79], v[252:255], a[96:99], v[64:79]
  buffer_load_dwordx4 v5, s[12:15], s74 offen offset:2048 lds
  ds_read_b64_tr_b16 a[72:73], v16 offset:2048
  ds_read_b64_tr_b16 a[74:75], v16 offset:2560
  v_mfma_f32_32x32x16_bf16 v[80:95], a[100:103], v[252:255], v[80:95]
  ds_read_b64_tr_b16 a[76:77], v17 offset:2048
  ds_read_b64_tr_b16 a[78:79], v17 offset:2560
  v_mfma_f32_32x32x16_bf16 v[96:111], a[104:107], v[252:255], v[96:111]
  v_mfma_f32_32x32x16_bf16 v[112:127], a[108:111], v[252:255], v[112:127]
  buffer_load_dwordx4 v6, s[12:15], s74 offen offset:3072 lds
  s_waitcnt lgkmcnt(8)
  v_mfma_f32_32x32x16_bf16 a[0:15], a[112:115], v[128:131], 0
  ds_read_b64_tr_b16 a[88:89], v14 offset:4096
  ds_read_b64_tr_b16 a[90:91], v14 offset:4608
  s_add_u32 s74, s68, 1032192
  s_add_u32 m0, s69, 36864
  v_mfma_f32_32x32x16_bf16 a[16:31], a[116:119], v[128:131], 0
  buffer_load_dwordx4 v11, s[12:15], s74 offen offset:0 lds
  ds_read_b64_tr_b16 a[92:93], v15 offset:4096
  ds_read_b64_tr_b16 a[94:95], v15 offset:4608
  v_mfma_f32_32x32x16_bf16 a[32:47], a[120:123], v[128:131], 0
  ds_read_b64_tr_b16 a[96:97], v16 offset:4096
  ds_read_b64_tr_b16 a[98:99], v16 offset:4608
  v_mfma_f32_32x32x16_bf16 a[48:63], a[124:127], v[128:131], 0
  ds_read_b64_tr_b16 a[100:101], v17 offset:4096
  ds_read_b64_tr_b16 a[102:103], v17 offset:4608
  s_waitcnt lgkmcnt(8)
  v_mfma_f32_32x32x16_bf16 a[0:15], a[64:67], v[132:135], a[0:15]
  ds_read_b64_tr_b16 a[112:113], v14 offset:6144
  ds_read_b64_tr_b16 a[114:115], v14 offset:6656
  v_mul_f32 v32, s71, v32
  v_mul_f32 v33, s71, v33
  v_mul_f32 v34, s71, v34
  v_mul_f32 v35, s71, v35
  v_mfma_f32_32x32x16_bf16 a[16:31], a[68:71], v[132:135], a[16:31]
  buffer_load_dwordx4 v4, s[12:15], s74 offen offset:1024 lds
  ds_read_b64_tr_b16 a[116:117], v15 offset:6144
  ds_read_b64_tr_b16 a[118:119], v15 offset:6656
  v_mul_f32 v36, s71, v36
  v_mul_f32 v37, s71, v37
  v_mul_f32 v38, s71, v38
  v_mul_f32 v39, s71, v39
  v_mfma_f32_32x32x16_bf16 a[32:47], a[72:75], v[132:135], a[32:47]
  ds_read_b64_tr_b16 a[120:121], v16 offset:6144
  ds_read_b64_tr_b16 a[122:123], v16 offset:6656
  v_cvt_pk_bf16_f32 v32, v32, v33
  v_cvt_pk_bf16_f32 v33, v34, v35
  v_cvt_pk_bf16_f32 v34, v36, v37
  v_cvt_pk_bf16_f32 v35, v38, v39
  v_mfma_f32_32x32x16_bf16 a[48:63], a[76:79], v[132:135], a[48:63]
  ds_read_b64_tr_b16 a[124:125], v17 offset:6144
  ds_read_b64_tr_b16 a[126:127], v17 offset:6656
  s_add_u32 s75, s76, 0
  s_waitcnt lgkmcnt(8)
  v_mfma_f32_32x32x16_bf16 a[0:15], a[88:91], v[136:139], a[0:15]
  ds_read_b64_tr_b16 a[64:65], v14 offset:8192
  ds_read_b64_tr_b16 a[66:67], v14 offset:8704
  buffer_store_dwordx4 v[32:35], v21, s[16:19], s75 offen sc0 sc1
  v_mul_f32 v40, s71, v40
  v_mul_f32 v41, s71, v41
  v_mul_f32 v42, s71, v42
  v_mfma_f32_32x32x16_bf16 a[16:31], a[92:95], v[136:139], a[16:31]
  buffer_load_dwordx4 v5, s[12:15], s74 offen offset:2048 lds
  ds_read_b64_tr_b16 a[68:69], v15 offset:8192
  ds_read_b64_tr_b16 a[70:71], v15 offset:8704
  v_mul_f32 v43, s71, v43
  v_mul_f32 v44, s71, v44
  v_mul_f32 v45, s71, v45
  v_mul_f32 v46, s71, v46
  v_mfma_f32_32x32x16_bf16 a[32:47], a[96:99], v[136:139], a[32:47]
  ds_read_b64_tr_b16 a[72:73], v16 offset:8192
  ds_read_b64_tr_b16 a[74:75], v16 offset:8704
  v_mul_f32 v47, s71, v47
  v_cvt_pk_bf16_f32 v40, v40, v41
  v_cvt_pk_bf16_f32 v41, v42, v43
  v_cvt_pk_bf16_f32 v42, v44, v45
  v_mfma_f32_32x32x16_bf16 a[48:63], a[100:103], v[136:139], a[48:63]
  ds_read_b64_tr_b16 a[76:77], v17 offset:8192
  ds_read_b64_tr_b16 a[78:79], v17 offset:8704
  v_cvt_pk_bf16_f32 v43, v46, v47
  s_add_u32 s75, s76, 65536
  s_waitcnt lgkmcnt(8)
  v_mfma_f32_32x32x16_bf16 a[0:15], a[112:115], v[140:143], a[0:15]
  ds_read_b64_tr_b16 a[88:89], v14 offset:10240
  ds_read_b64_tr_b16 a[90:91], v14 offset:10752
  buffer_store_dwordx4 v[40:43], v21, s[16:19], s75 offen sc0 sc1
  v_mul_f32 v24, v80, v80
  v_mul_f32 v25, v81, v81
  v_mul_f32 v26, v82, v82
  v_mfma_f32_32x32x16_bf16 a[16:31], a[116:119], v[140:143], a[16:31]
  buffer_load_dwordx4 v6, s[12:15], s74 offen offset:3072 lds
  ds_read_b64_tr_b16 a[92:93], v15 offset:10240
  ds_read_b64_tr_b16 a[94:95], v15 offset:10752
  v_mul_f32 v27, v83, v83
  v_fma_f32 v24, v24, s70, v23
  v_fma_f32 v25, v25, s70, v23
  v_fma_f32 v26, v26, s70, v23
  v_mfma_f32_32x32x16_bf16 a[32:47], a[120:123], v[140:143], a[32:47]
  ds_read_b64_tr_b16 a[96:97], v16 offset:10240
  ds_read_b64_tr_b16 a[98:99], v16 offset:10752
  v_fma_f32 v27, v27, s70, v23
  v_mul_f32 v24, v24, v80
  v_mul_f32 v25, v25, v81
  v_mul_f32 v26, v26, v82
  v_mfma_f32_32x32x16_bf16 a[48:63], a[124:127], v[140:143], a[48:63]
  ds_read_b64_tr_b16 a[100:101], v17 offset:10240
  ds_read_b64_tr_b16 a[102:103], v17 offset:10752
  v_mul_f32 v27, v27, v83
  v_exp_f32 v24, v24
  v_exp_f32 v25, v25
  s_waitcnt lgkmcnt(8)
  v_mfma_f32_32x32x16_bf16 a[0:15], a[64:67], v[144:147], a[0:15]
  ds_read_b64_tr_b16 a[112:113], v14 offset:12288
  ds_read_b64_tr_b16 a[114:115], v14 offset:12800
  v_exp_f32 v26, v26
  v_exp_f32 v27, v27
  v_mfma_f32_32x32x16_bf16 a[16:31], a[68:71], v[144:147], a[16:31]
  ds_read_b64_tr_b16 a[116:117], v15 offset:12288
  ds_read_b64_tr_b16 a[118:119], v15 offset:12800
  v_mul_f32 v88, v80, v88
  v_mul_f32 v89, v81, v89
  v_mul_f32 v90, v82, v90
  v_mul_f32 v91, v83, v91
  v_mfma_f32_32x32x16_bf16 a[32:47], a[72:75], v[144:147], a[32:47]
  ds_read_b64_tr_b16 a[120:121], v16 offset:12288
  ds_read_b64_tr_b16 a[122:123], v16 offset:12800
  v_add_f32 v24, 1.0, v24
  v_add_f32 v25, 1.0, v25
  v_add_f32 v26, 1.0, v26
  v_add_f32 v27, 1.0, v27
  v_mfma_f32_32x32x16_bf16 a[48:63], a[76:79], v[144:147], a[48:63]
  ds_read_b64_tr_b16 a[124:125], v17 offset:12288
  ds_read_b64_tr_b16 a[126:127], v17 offset:12800
  v_rcp_f32 v24, v24
  v_rcp_f32 v25, v25
  s_waitcnt lgkmcnt(8)
  v_mfma_f32_32x32x16_bf16 a[0:15], a[88:91], v[148:151], a[0:15]
  ds_read_b64_tr_b16 a[64:65], v14 offset:14336
  ds_read_b64_tr_b16 a[66:67], v14 offset:14848
  v_rcp_f32 v26, v26
  v_rcp_f32 v27, v27
  v_mfma_f32_32x32x16_bf16 a[16:31], a[92:95], v[148:151], a[16:31]
  ds_read_b64_tr_b16 a[68:69], v15 offset:14336
  ds_read_b64_tr_b16 a[70:71], v15 offset:14848
  v_mul_f32 v80, v88, v24
  v_mul_f32 v81, v89, v25
  v_mul_f32 v82, v90, v26
  v_mul_f32 v83, v91, v27
  v_mfma_f32_32x32x16_bf16 a[32:47], a[96:99], v[148:151], a[32:47]
  ds_read_b64_tr_b16 a[72:73], v16 offset:14336
  ds_read_b64_tr_b16 a[74:75], v16 offset:14848
  v_mul_f32 v48, s71, v48
  v_mul_f32 v49, s71, v49
  v_mul_f32 v50, s71, v50
  v_mul_f32 v51, s71, v51
  v_mfma_f32_32x32x16_bf16 a[48:63], a[100:103], v[148:151], a[48:63]
  ds_read_b64_tr_b16 a[76:77], v17 offset:14336
  ds_read_b64_tr_b16 a[78:79], v17 offset:14848
  v_mul_f32 v52, s71, v52
  v_mul_f32 v53, s71, v53
  v_mul_f32 v54, s71, v54
  v_mul_f32 v55, s71, v55
  s_waitcnt lgkmcnt(8)
  v_mfma_f32_32x32x16_bf16 a[0:15], a[112:115], v[152:155], a[0:15]
  s_waitcnt vmcnt(10)
  s_barrier
  v_add_u32 v14, 0xfffe8000, v14
  v_add_u32 v15, 0xfffe8000, v15
  v_add_u32 v16, 0xfffe8000, v16
  v_add_u32 v17, 0xfffe8000, v17
  ds_read_b64_tr_b16 a[88:89], v14 offset:0
  ds_read_b64_tr_b16 a[90:91], v14 offset:512
  v_cvt_pk_bf16_f32 v48, v48, v49
  v_cvt_pk_bf16_f32 v49, v50, v51
  v_cvt_pk_bf16_f32 v50, v52, v53
  v_cvt_pk_bf16_f32 v51, v54, v55
  s_add_u32 s74, s68, 1376256
  s_add_u32 m0, s69, 65536
  v_mfma_f32_32x32x16_bf16 a[16:31], a[116:119], v[152:155], a[16:31]
  buffer_load_dwordx4 v11, s[12:15], s74 offen offset:0 lds
  ds_read_b64_tr_b16 a[92:93], v15 offset:0
  ds_read_b64_tr_b16 a[94:95], v15 offset:512
  s_add_u32 s75, s76, 131072
  v_mfma_f32_32x32x16_bf16 a[32:47], a[120:123], v[152:155], a[32:47]
  ds_read_b64_tr_b16 a[96:97], v16 offset:0
  ds_read_b64_tr_b16 a[98:99], v16 offset:512
  buffer_store_dwordx4 v[48:51], v21, s[16:19], s75 offen sc0 sc1
  v_mul_f32 v56, s71, v56
  v_mul_f32 v57, s71, v57
  v_mul_f32 v58, s71, v58
  v_mfma_f32_32x32x16_bf16 a[48:63], a[124:127], v[152:155], a[48:63]
  buffer_load_dwordx4 v4, s[12:15], s74 offen offset:1024 lds
  ds_read_b64_tr_b16 a[100:101], v17 offset:0
  ds_read_b64_tr_b16 a[102:103], v17 offset:512
  v_mul_f32 v59, s71, v59
  v_mul_f32 v60, s71, v60
  v_mul_f32 v61, s71, v61
  v_mul_f32 v62, s71, v62
  s_waitcnt lgkmcnt(8)
  v_mfma_f32_32x32x16_bf16 a[0:15], a[64:67], v[156:159], a[0:15]
  ds_read_b64_tr_b16 a[112:113], v14 offset:2048
  ds_read_b64_tr_b16 a[114:115], v14 offset:2560
  v_mul_f32 v63, s71, v63
  v_cvt_pk_bf16_f32 v56, v56, v57
  v_cvt_pk_bf16_f32 v57, v58, v59
  v_cvt_pk_bf16_f32 v58, v60, v61
  v_mfma_f32_32x32x16_bf16 a[16:31], a[68:71], v[156:159], a[16:31]
  buffer_load_dwordx4 v5, s[12:15], s74 offen offset:2048 lds
  ds_read_b64_tr_b16 a[116:117], v15 offset:2048
  ds_read_b64_tr_b16 a[118:119], v15 offset:2560
  v_cvt_pk_bf16_f32 v59, v62, v63
  s_add_u32 s75, s76, 196608
  v_mfma_f32_32x32x16_bf16 a[32:47], a[72:75], v[156:159], a[32:47]
  ds_read_b64_tr_b16 a[120:121], v16 offset:2048
  ds_read_b64_tr_b16 a[122:123], v16 offset:2560
  buffer_store_dwordx4 v[56:59], v21, s[16:19], s75 offen sc0 sc1
  v_mul_f32 v28, v84, v84
  v_mul_f32 v29, v85, v85
  v_mul_f32 v30, v86, v86
  v_mfma_f32_32x32x16_bf16 a[48:63], a[76:79], v[156:159], a[48:63]
  buffer_load_dwordx4 v6, s[12:15], s74 offen offset:3072 lds
  ds_read_b64_tr_b16 a[124:125], v17 offset:2048
  ds_read_b64_tr_b16 a[126:127], v17 offset:2560
  v_mul_f32 v31, v87, v87
  v_fma_f32 v28, v28, s70, v23
  v_fma_f32 v29, v29, s70, v23
  v_fma_f32 v30, v30, s70, v23
  s_waitcnt lgkmcnt(8)
  v_mfma_f32_32x32x16_bf16 a[0:15], a[88:91], v[160:163], a[0:15]
  ds_read_b64_tr_b16 a[64:65], v14 offset:4096
  ds_read_b64_tr_b16 a[66:67], v14 offset:4608
  v_fma_f32 v31, v31, s70, v23
  v_mul_f32 v28, v28, v84
  v_mul_f32 v29, v29, v85
  v_mul_f32 v30, v30, v86
  s_add_u32 s74, s68, 1490944
  s_add_u32 m0, s69, 69632
  v_mfma_f32_32x32x16_bf16 a[16:31], a[92:95], v[160:163], a[16:31]
  buffer_load_dwordx4 v11, s[12:15], s74 offen offset:0 lds
  ds_read_b64_tr_b16 a[68:69], v15 offset:4096
  ds_read_b64_tr_b16 a[70:71], v15 offset:4608
  v_mul_f32 v31, v31, v87
  v_exp_f32 v28, v28
  v_exp_f32 v29, v29
  v_mfma_f32_32x32x16_bf16 a[32:47], a[96:99], v[160:163], a[32:47]
  ds_read_b64_tr_b16 a[72:73], v16 offset:4096
  ds_read_b64_tr_b16 a[74:75], v16 offset:4608
  v_exp_f32 v30, v30
  v_exp_f32 v31, v31
  v_mfma_f32_32x32x16_bf16 a[48:63], a[100:103], v[160:163], a[48:63]
  ds_read_b64_tr_b16 a[76:77], v17 offset:4096
  ds_read_b64_tr_b16 a[78:79], v17 offset:4608
  v_mul_f32 v92, v84, v92
  v_mul_f32 v93, v85, v93
  v_mul_f32 v94, v86, v94
  v_mul_f32 v95, v87, v95
  s_waitcnt lgkmcnt(8)
  v_mfma_f32_32x32x16_bf16 a[0:15], a[112:115], v[164:167], a[0:15]
  ds_read_b64_tr_b16 a[88:89], v14 offset:6144
  ds_read_b64_tr_b16 a[90:91], v14 offset:6656
  v_add_f32 v28, 1.0, v28
  v_add_f32 v29, 1.0, v29
  v_add_f32 v30, 1.0, v30
  v_add_f32 v31, 1.0, v31
  v_mfma_f32_32x32x16_bf16 a[16:31], a[116:119], v[164:167], a[16:31]
  buffer_load_dwordx4 v4, s[12:15], s74 offen offset:1024 lds
  ds_read_b64_tr_b16 a[92:93], v15 offset:6144
  ds_read_b64_tr_b16 a[94:95], v15 offset:6656
  v_rcp_f32 v28, v28
  v_rcp_f32 v29, v29
  v_mfma_f32_32x32x16_bf16 a[32:47], a[120:123], v[164:167], a[32:47]
  ds_read_b64_tr_b16 a[96:97], v16 offset:6144
  ds_read_b64_tr_b16 a[98:99], v16 offset:6656
  v_rcp_f32 v30, v30
  v_rcp_f32 v31, v31
  v_mfma_f32_32x32x16_bf16 a[48:63], a[124:127], v[164:167], a[48:63]
  ds_read_b64_tr_b16 a[100:101], v17 offset:6144
  ds_read_b64_tr_b16 a[102:103], v17 offset:6656
  v_mul_f32 v84, v92, v28
  v_mul_f32 v85, v93, v29
  v_mul_f32 v86, v94, v30
  v_mul_f32 v87, v95, v31
  s_waitcnt lgkmcnt(8)
  v_mfma_f32_32x32x16_bf16 a[0:15], a[64:67], v[168:171], a[0:15]
  ds_read_b64_tr_b16 a[112:113], v14 offset:8192
  ds_read_b64_tr_b16 a[114:115], v14 offset:8704
  v_cvt_pk_bf16_f32 v64, v64, v65
  v_cvt_pk_bf16_f32 v65, v66, v67
  v_cvt_pk_bf16_f32 v66, v68, v69
  v_mfma_f32_32x32x16_bf16 a[16:31], a[68:71], v[168:171], a[16:31]
  buffer_load_dwordx4 v5, s[12:15], s74 offen offset:2048 lds
  ds_read_b64_tr_b16 a[116:117], v15 offset:8192
  ds_read_b64_tr_b16 a[118:119], v15 offset:8704
  v_cvt_pk_bf16_f32 v67, v70, v71
  s_add_u32 s75, s77, 4194304
  v_mfma_f32_32x32x16_bf16 a[32:47], a[72:75], v[168:171], a[32:47]
  ds_read_b64_tr_b16 a[120:121], v16 offset:8192
  ds_read_b64_tr_b16 a[122:123], v16 offset:8704
  buffer_store_dwordx4 v[64:67], v22, s[16:19], s75 offen sc0 sc1
  v_cvt_pk_bf16_f32 v72, v72, v73
  v_cvt_pk_bf16_f32 v73, v74, v75
  v_mfma_f32_32x32x16_bf16 a[48:63], a[76:79], v[168:171], a[48:63]
  ds_read_b64_tr_b16 a[124:125], v17 offset:8192
  ds_read_b64_tr_b16 a[126:127], v17 offset:8704
  v_cvt_pk_bf16_f32 v74, v76, v77
  v_cvt_pk_bf16_f32 v75, v78, v79
  s_add_u32 s75, s77, 4194880
  s_waitcnt lgkmcnt(8)
  v_mfma_f32_32x32x16_bf16 a[0:15], a[88:91], v[172:175], a[0:15]
  ds_read_b64_tr_b16 a[64:65], v14 offset:10240
  ds_read_b64_tr_b16 a[66:67], v14 offset:10752
  buffer_store_dwordx4 v[72:75], v22, s[16:19], s75 offen sc0 sc1
  v_cvt_pk_bf16_f32 v80, v80, v81
  v_cvt_pk_bf16_f32 v81, v82, v83
  v_mfma_f32_32x32x16_bf16 a[16:31], a[92:95], v[172:175], a[16:31]
  buffer_load_dwordx4 v6, s[12:15], s74 offen offset:3072 lds
  ds_read_b64_tr_b16 a[68:69], v15 offset:10240
  ds_read_b64_tr_b16 a[70:71], v15 offset:10752
  v_cvt_pk_bf16_f32 v82, v84, v85
  v_cvt_pk_bf16_f32 v83, v86, v87
  s_add_u32 s75, s78, 0
  v_mfma_f32_32x32x16_bf16 a[32:47], a[96:99], v[172:175], a[32:47]
  ds_read_b64_tr_b16 a[72:73], v16 offset:10240
  ds_read_b64_tr_b16 a[74:75], v16 offset:10752
  buffer_store_dwordx4 v[80:83], v21, s[16:19], s75 offen sc0 sc1
  v_and_b32 v28, 1, v1
  v_mul_u32_u24 v28, 288, v28
  v_mfma_f32_32x32x16_bf16 a[48:63], a[100:103], v[172:175], a[48:63]
  ds_read_b64_tr_b16 a[76:77], v17 offset:10240
  ds_read_b64_tr_b16 a[78:79], v17 offset:10752
  v_bfe_u32 v29, v1, 1, 1
  v_mul_u32_u24 v29, 576, v29
  v_bfe_u32 v30, v1, 2, 1
  v_mul_lo_u32 v30, s84, v30
  s_waitcnt lgkmcnt(8)
  v_mfma_f32_32x32x16_bf16 a[0:15], a[112:115], v[176:179], a[0:15]
  ds_read_b64_tr_b16 a[88:89], v14 offset:12288
  ds_read_b64_tr_b16 a[90:91], v14 offset:12800
  v_add3_u32 v28, v28, v29, v30
  v_bfe_u32 v29, v1, 3, 1
  v_lshl_add_u32 v28, v29, 4, v28
  v_mfma_f32_32x32x16_bf16 a[16:31], a[116:119], v[176:179], a[16:31]
  ds_read_b64_tr_b16 a[92:93], v15 offset:12288
  ds_read_b64_tr_b16 a[94:95], v15 offset:12800
  v_subrev_u32 v29, 1, v29
  v_and_b32 v24, 0x3f803f80, v29
  v_mov_b32 v25, v24
  v_mfma_f32_32x32x16_bf16 a[32:47], a[120:123], v[176:179], a[32:47]
  ds_read_b64_tr_b16 a[96:97], v16 offset:12288
  ds_read_b64_tr_b16 a[98:99], v16 offset:12800
  v_mov_b32 v26, v24
  v_mov_b32 v27, v24
  s_add_u32 s75, s77, 4194560
  v_mfma_f32_32x32x16_bf16 a[48:63], a[124:127], v[176:179], a[48:63]
  ds_read_b64_tr_b16 a[100:101], v17 offset:12288
  ds_read_b64_tr_b16 a[102:103], v17 offset:12800
  s_mov_b64 exec, 0xffff
  buffer_store_dwordx4 v[24:27], v28, s[16:19], s75 offen sc0 sc1
  s_mov_b64 exec, -1
  v_mov_b32 v3, 0
  s_waitcnt lgkmcnt(8)
  v_mfma_f32_32x32x16_bf16 a[0:15], a[64:67], v[180:183], a[0:15]
  ds_read_b64_tr_b16 a[112:113], v14 offset:14336
  ds_read_b64_tr_b16 a[114:115], v14 offset:14848
  buffer_load_dword v2, v3, s[32:35], 0 offen sc1
  v_lshlrev_b32 v28, 7, v1
  s_mul_i32 s85, s2, 7168
  v_mfma_f32_32x32x16_bf16 a[16:31], a[68:71], v[180:183], a[16:31]
  ds_read_b64_tr_b16 a[116:117], v15 offset:14336
  ds_read_b64_tr_b16 a[118:119], v15 offset:14848
  s_mul_i32 s86, s56, 1792
  s_add_u32 s85, s85, s86
  s_lshl_b32 s87, s2, 11
  v_mfma_f32_32x32x16_bf16 a[32:47], a[72:75], v[180:183], a[32:47]
  ds_read_b64_tr_b16 a[120:121], v16 offset:14336
  ds_read_b64_tr_b16 a[122:123], v16 offset:14848
  s_lshl_b32 s86, s56, 9
  s_add_u32 s87, s87, s86
  v_mfma_f32_32x32x16_bf16 a[48:63], a[76:79], v[180:183], a[48:63]
  ds_read_b64_tr_b16 a[124:125], v17 offset:14336
  ds_read_b64_tr_b16 a[126:127], v17 offset:14848
  s_mov_b64 exec, 0x3fff
  buffer_load_dword a136, v28, s[20:23], s85 offen
  s_mov_b64 exec, 0xf
  buffer_load_dword a137, v28, s[24:27], s87 offen
  s_mov_b64 exec, -1
  s_waitcnt lgkmcnt(8)
  v_mfma_f32_32x32x16_bf16 a[0:15], a[88:91], v[184:187], a[0:15]
  s_waitcnt vmcnt(17)
  s_barrier
  v_add_u32 v14, 0x00008000, v14
  v_add_u32 v15, 0x00008000, v15
  v_add_u32 v16, 0x00008000, v16
  v_add_u32 v17, 0x00008000, v17
  ds_read_b64_tr_b16 a[64:65], v14 offset:0
  ds_read_b64_tr_b16 a[66:67], v14 offset:512
  v_add_u32 v10, 0, v21
  v_and_b32 v24, 31, v1
  v_min_u32 v24, 17, v24
  v_mfma_f32_32x32x16_bf16 a[16:31], a[92:95], v[184:187], a[16:31]
  ds_read_b64_tr_b16 a[68:69], v15 offset:0
  ds_read_b64_tr_b16 a[70:71], v15 offset:512
  v_lshlrev_b32 v24, 4, v24
  v_lshrrev_b32 v25, 5, v1
  v_mul_u32_u24 v25, 288, v25
  v_mfma_f32_32x32x16_bf16 a[32:47], a[96:99], v[184:187], a[32:47]
  ds_read_b64_tr_b16 a[72:73], v16 offset:0
  ds_read_b64_tr_b16 a[74:75], v16 offset:512
  v_add_u32 v24, v24, v25
  v_add_u32 v0, 65536, v24
  v_lshrrev_b32 v24, 3, v1
  v_mfma_f32_32x32x16_bf16 a[48:63], a[100:103], v[184:187], a[48:63]
  ds_read_b64_tr_b16 a[76:77], v17 offset:0
  ds_read_b64_tr_b16 a[78:79], v17 offset:512
  v_and_b32 v25, 7, v1
  v_and_b32 v26, 2, v24
  v_lshlrev_b32 v26, 1, v26
  v_xor_b32 v25, v25, v26
  s_waitcnt lgkmcnt(8)
  v_mfma_f32_32x32x16_bf16 a[0:15], a[112:115], v[188:191], a[0:15]
  ds_read_b64_tr_b16 a[88:89], v14 offset:2048
  ds_read_b64_tr_b16 a[90:91], v14 offset:2560
  v_lshlrev_b32 v24, 10, v24
  v_lshl_add_u32 v4, v25, 4, v24
  v_add_u32 v5, 7168, v4
  v_mfma_f32_32x32x16_bf16 a[16:31], a[116:119], v[188:191], a[16:31]
  ds_read_b64_tr_b16 a[92:93], v15 offset:2048
  ds_read_b64_tr_b16 a[94:95], v15 offset:2560
  v_add_u32 v6, 14336, v4
  v_add_u32 v7, 21504, v4
  v_and_b32 v24, 15, v1
  v_mfma_f32_32x32x16_bf16 a[32:47], a[120:123], v[188:191], a[32:47]
  ds_read_b64_tr_b16 a[96:97], v16 offset:2048
  ds_read_b64_tr_b16 a[98:99], v16 offset:2560
  v_lshrrev_b32 v25, 2, v24
  v_lshrrev_b32 v26, 5, v1
  v_lshl_add_u32 v25, v26, 2, v25
  v_mfma_f32_32x32x16_bf16 a[48:63], a[124:127], v[188:191], a[48:63]
  ds_read_b64_tr_b16 a[100:101], v17 offset:2048
  ds_read_b64_tr_b16 a[102:103], v17 offset:2560
  v_bfe_u32 v26, v24, 1, 1
  v_bfe_u32 v27, v1, 4, 1
  v_lshl_add_u32 v26, v27, 1, v26
  v_lshrrev_b32 v27, 3, v24
  s_waitcnt lgkmcnt(8)
  v_mfma_f32_32x32x16_bf16 a[0:15], a[64:67], v[192:195], a[0:15]
  ds_read_b64_tr_b16 a[112:113], v14 offset:4096
  ds_read_b64_tr_b16 a[114:115], v14 offset:4608
  v_lshl_add_u32 v26, v27, 2, v26
  v_lshlrev_b32 v26, 4, v26
  v_lshl_add_u32 v26, v25, 7, v26
  v_mfma_f32_32x32x16_bf16 a[16:31], a[68:71], v[192:195], a[16:31]
  ds_read_b64_tr_b16 a[116:117], v15 offset:4096
  ds_read_b64_tr_b16 a[118:119], v15 offset:4608
  v_and_b32 v27, 1, v24
  v_lshl_add_u32 v26, v27, 3, v26
  s_lshl_b32 s92, s56, 12
  v_mfma_f32_32x32x16_bf16 a[32:47], a[72:75], v[192:195], a[32:47]
  ds_read_b64_tr_b16 a[120:121], v16 offset:4096
  ds_read_b64_tr_b16 a[122:123], v16 offset:4608
  s_add_u32 s92, s92, 139264
  v_add_u32 v8, s92, v26
  v_xor_b32 v9, 64, v8
  v_mfma_f32_32x32x16_bf16 a[48:63], a[76:79], v[192:195], a[48:63]
  ds_read_b64_tr_b16 a[124:125], v17 offset:4096
  ds_read_b64_tr_b16 a[126:127], v17 offset:4608
  v_mov_b32 v24, 0
  v_mov_b32 v25, 0
  v_mov_b32 v26, 0
  v_mov_b32 v27, 0
  s_waitcnt lgkmcnt(8)
  v_mfma_f32_32x32x16_bf16 a[0:15], a[88:91], v[196:199], a[0:15]
  ds_read_b64_tr_b16 a[64:65], v14 offset:6144
  ds_read_b64_tr_b16 a[66:67], v14 offset:6656
  v_add_u32 v28, s92, v21
  v_mfma_f32_32x32x16_bf16 a[16:31], a[92:95], v[196:199], a[16:31]
  ds_read_b64_tr_b16 a[68:69], v15 offset:6144
  ds_read_b64_tr_b16 a[70:71], v15 offset:6656
  ds_write_b128 v28, v[24:27] offset:0
  ds_write_b128 v28, v[24:27] offset:1024
  ds_write_b128 v28, v[24:27] offset:2048
  ds_write_b128 v28, v[24:27] offset:3072
  v_mfma_f32_32x32x16_bf16 a[32:47], a[96:99], v[196:199], a[32:47]
  ds_read_b64_tr_b16 a[72:73], v16 offset:6144
  ds_read_b64_tr_b16 a[74:75], v16 offset:6656
  v_mul_f32 v24, v96, v96
  v_mul_f32 v25, v97, v97
  v_mul_f32 v26, v98, v98
  v_mfma_f32_32x32x16_bf16 a[48:63], a[100:103], v[196:199], a[48:63]
  ds_read_b64_tr_b16 a[76:77], v17 offset:6144
  ds_read_b64_tr_b16 a[78:79], v17 offset:6656
  v_mul_f32 v27, v99, v99
  v_fma_f32 v24, v24, s70, v23
  v_fma_f32 v25, v25, s70, v23
  v_fma_f32 v26, v26, s70, v23
  s_waitcnt lgkmcnt(12)
  v_mfma_f32_32x32x16_bf16 a[0:15], a[112:115], v[200:203], a[0:15]
  ds_read_b64_tr_b16 a[88:89], v14 offset:8192
  ds_read_b64_tr_b16 a[90:91], v14 offset:8704
  v_fma_f32 v27, v27, s70, v23
  v_mul_f32 v24, v24, v96
  v_mul_f32 v25, v25, v97
  v_mfma_f32_32x32x16_bf16 a[16:31], a[116:119], v[200:203], a[16:31]
  ds_read_b64_tr_b16 a[92:93], v15 offset:8192
  ds_read_b64_tr_b16 a[94:95], v15 offset:8704
  v_mul_f32 v26, v26, v98
  v_mul_f32 v27, v27, v99
  v_exp_f32 v24, v24
  v_mfma_f32_32x32x16_bf16 a[32:47], a[120:123], v[200:203], a[32:47]
  ds_read_b64_tr_b16 a[96:97], v16 offset:8192
  ds_read_b64_tr_b16 a[98:99], v16 offset:8704
  v_exp_f32 v25, v25
  v_exp_f32 v26, v26
  v_mfma_f32_32x32x16_bf16 a[48:63], a[124:127], v[200:203], a[48:63]
  ds_read_b64_tr_b16 a[100:101], v17 offset:8192
  ds_read_b64_tr_b16 a[102:103], v17 offset:8704
  v_exp_f32 v27, v27
  v_mul_f32 v104, v96, v104
  v_mul_f32 v105, v97, v105
  s_waitcnt lgkmcnt(8)
  v_mfma_f32_32x32x16_bf16 a[0:15], a[64:67], v[204:207], a[0:15]
  ds_read_b64_tr_b16 a[112:113], v14 offset:10240
  ds_read_b64_tr_b16 a[114:115], v14 offset:10752
  v_mul_f32 v106, v98, v106
  v_mul_f32 v107, v99, v107
  v_add_f32 v24, 1.0, v24
  v_mfma_f32_32x32x16_bf16 a[16:31], a[68:71], v[204:207], a[16:31]
  ds_read_b64_tr_b16 a[116:117], v15 offset:10240
  ds_read_b64_tr_b16 a[118:119], v15 offset:10752
  v_add_f32 v25, 1.0, v25
  v_add_f32 v26, 1.0, v26
  v_add_f32 v27, 1.0, v27
  v_mfma_f32_32x32x16_bf16 a[32:47], a[72:75], v[204:207], a[32:47]
  ds_read_b64_tr_b16 a[120:121], v16 offset:10240
  ds_read_b64_tr_b16 a[122:123], v16 offset:10752
  v_rcp_f32 v24, v24
  v_rcp_f32 v25, v25
  v_mfma_f32_32x32x16_bf16 a[48:63], a[76:79], v[204:207], a[48:63]
  ds_read_b64_tr_b16 a[124:125], v17 offset:10240
  ds_read_b64_tr_b16 a[126:127], v17 offset:10752
  v_rcp_f32 v26, v26
  v_rcp_f32 v27, v27
  s_waitcnt lgkmcnt(8)
  v_mfma_f32_32x32x16_bf16 a[0:15], a[88:91], v[208:211], a[0:15]
  ds_read_b64_tr_b16 a[64:65], v14 offset:12288
  ds_read_b64_tr_b16 a[66:67], v14 offset:12800
  v_mul_f32 v96, v104, v24
  v_mul_f32 v97, v105, v25
  v_mul_f32 v98, v106, v26
  v_mfma_f32_32x32x16_bf16 a[16:31], a[92:95], v[208:211], a[16:31]
  ds_read_b64_tr_b16 a[68:69], v15 offset:12288
  ds_read_b64_tr_b16 a[70:71], v15 offset:12800
  v_mul_f32 v99, v107, v27
  v_mul_f32 v28, v100, v100
  v_mul_f32 v29, v101, v101
  v_mfma_f32_32x32x16_bf16 a[32:47], a[96:99], v[208:211], a[32:47]
  ds_read_b64_tr_b16 a[72:73], v16 offset:12288
  ds_read_b64_tr_b16 a[74:75], v16 offset:12800
  v_mul_f32 v30, v102, v102
  v_mul_f32 v31, v103, v103
  v_fma_f32 v28, v28, s70, v23
  v_mfma_f32_32x32x16_bf16 a[48:63], a[100:103], v[208:211], a[48:63]
  ds_read_b64_tr_b16 a[76:77], v17 offset:12288
  ds_read_b64_tr_b16 a[78:79], v17 offset:12800
  v_fma_f32 v29, v29, s70, v23
  v_fma_f32 v30, v30, s70, v23
  v_fma_f32 v31, v31, s70, v23
  v_mul_f32 v28, v28, v100
  s_waitcnt lgkmcnt(8)
  v_mfma_f32_32x32x16_bf16 a[0:15], a[112:115], v[212:215], a[0:15]
  ds_read_b64_tr_b16 a[88:89], v14 offset:14336
  ds_read_b64_tr_b16 a[90:91], v14 offset:14848
  v_mul_f32 v29, v29, v101
  v_mul_f32 v30, v30, v102
  v_mul_f32 v31, v31, v103
  v_mfma_f32_32x32x16_bf16 a[16:31], a[116:119], v[212:215], a[16:31]
  ds_read_b64_tr_b16 a[92:93], v15 offset:14336
  ds_read_b64_tr_b16 a[94:95], v15 offset:14848
  v_exp_f32 v28, v28
  v_exp_f32 v29, v29
  v_mfma_f32_32x32x16_bf16 a[32:47], a[120:123], v[212:215], a[32:47]
  ds_read_b64_tr_b16 a[96:97], v16 offset:14336
  ds_read_b64_tr_b16 a[98:99], v16 offset:14848
  v_exp_f32 v30, v30
  v_exp_f32 v31, v31
  v_mfma_f32_32x32x16_bf16 a[48:63], a[124:127], v[212:215], a[48:63]
  ds_read_b64_tr_b16 a[100:101], v17 offset:14336
  ds_read_b64_tr_b16 a[102:103], v17 offset:14848
  v_mul_f32 v108, v100, v108
  v_mul_f32 v109, v101, v109
  v_mul_f32 v110, v102, v110
  v_mul_f32 v111, v103, v111
  s_waitcnt lgkmcnt(8)
  v_mfma_f32_32x32x16_bf16 a[0:15], a[64:67], v[216:219], a[0:15]
  s_waitcnt vmcnt(5)
  s_waitcnt vmcnt(2)
  s_barrier
  v_readfirstlane_b32 s88, v2
  s_lshr_b32 s72, s60, 1
  s_lshl_b32 s72, s72, 8
  s_add_u32 s72, s72, 16777216
  s_cmp_ge_u32 s88, 1
  s_cbranch_scc1 L_polled_3
  s_mov_b32 s89, 0
L_poll_2:
  s_sleep 2
  buffer_load_dword v2, v3, s[32:35], 0 offen sc1
  s_add_u32 s89, s89, 1
  s_waitcnt vmcnt(0)
  v_readfirstlane_b32 s88, v2
  s_cmp_gt_u32 s89, 200000
  s_cbranch_scc1 L_polled_3
  s_cmp_ge_u32 s88, 1
  s_cbranch_scc0 L_poll_2
L_polled_3:
  s_cmp_lg_u32 s56, 0
  s_cbranch_scc1 L_sig_4
  v_mov_b32 v2, 1
  s_mov_b64 exec, 1
  buffer_atomic_add v2, v3, s[16:19], s72 offen sc1
  s_mov_b64 exec, -1
L_sig_4:
  v_add_u32 v14, 0x00008000, v14
  v_add_u32 v15, 0x00008000, v15
  v_add_u32 v16, 0x00008000, v16
  v_add_u32 v17, 0x00008000, v17
  ds_read_b64_tr_b16 a[112:113], v14 offset:0
  ds_read_b64_tr_b16 a[114:115], v14 offset:512
  v_add_f32 v28, 1.0, v28
  v_add_f32 v29, 1.0, v29
  v_add_f32 v30, 1.0, v30
  v_mfma_f32_32x32x16_bf16 a[16:31], a[68:71], v[216:219], a[16:31]
  ds_read_b64_tr_b16 a[116:117], v15 offset:0
  ds_read_b64_tr_b16 a[118:119], v15 offset:512
  v_add_f32 v31, 1.0, v31
  v_rcp_f32 v28, v28
  v_mfma_f32_32x32x16_bf16 a[32:47], a[72:75], v[216:219], a[32:47]
  ds_read_b64_tr_b16 a[120:121], v16 offset:0
  ds_read_b64_tr_b16 a[122:123], v16 offset:512
  v_rcp_f32 v29, v29
  v_rcp_f32 v30, v30
  v_mfma_f32_32x32x16_bf16 a[48:63], a[76:79], v[216:219], a[48:63]
  ds_read_b64_tr_b16 a[124:125], v17 offset:0
  ds_read_b64_tr_b16 a[126:127], v17 offset:512
  v_rcp_f32 v31, v31
  v_mul_f32 v100, v108, v28
  s_waitcnt lgkmcnt(8)
  v_mfma_f32_32x32x16_bf16 a[0:15], a[88:91], v[220:223], a[0:15]
  ds_read_b64_tr_b16 a[64:65], v14 offset:2048
  ds_read_b64_tr_b16 a[66:67], v14 offset:2560
  v_mul_f32 v101, v109, v29
  v_mul_f32 v102, v110, v30
  v_mul_f32 v103, v111, v31
  v_mfma_f32_32x32x16_bf16 a[16:31], a[92:95], v[220:223], a[16:31]
  ds_read_b64_tr_b16 a[68:69], v15 offset:2048
  ds_read_b64_tr_b16 a[70:71], v15 offset:2560
  v_cvt_pk_bf16_f32 v96, v96, v97
  v_cvt_pk_bf16_f32 v97, v98, v99
  v_cvt_pk_bf16_f32 v98, v100, v101
  v_mfma_f32_32x32x16_bf16 a[32:47], a[96:99], v[220:223], a[32:47]
  ds_read_b64_tr_b16 a[72:73], v16 offset:2048
  ds_read_b64_tr_b16 a[74:75], v16 offset:2560
  v_cvt_pk_bf16_f32 v99, v102, v103
  s_add_u32 s75, s78, 1024
  v_mfma_f32_32x32x16_bf16 a[48:63], a[100:103], v[220:223], a[48:63]
  ds_read_b64_tr_b16 a[76:77], v17 offset:2048
  ds_read_b64_tr_b16 a[78:79], v17 offset:2560
  buffer_store_dwordx4 v[96:99], v21, s[16:19], s75 offen sc0 sc1
  v_mul_f32 v24, v112, v112
  v_mul_f32 v25, v113, v113
  s_waitcnt lgkmcnt(8)
  v_mfma_f32_32x32x16_bf16 a[0:15], a[112:115], v[224:227], a[0:15]
  ds_read_b64_tr_b16 a[88:89], v14 offset:4096
  ds_read_b64_tr_b16 a[90:91], v14 offset:4608
  v_mul_f32 v26, v114, v114
  v_mul_f32 v27, v115, v115
  v_fma_f32 v24, v24, s70, v23
  v_mfma_f32_32x32x16_bf16 a[16:31], a[116:119], v[224:227], a[16:31]
  ds_read_b64_tr_b16 a[92:93], v15 offset:4096
  ds_read_b64_tr_b16 a[94:95], v15 offset:4608
  v_fma_f32 v25, v25, s70, v23
  v_fma_f32 v26, v26, s70, v23
  v_fma_f32 v27, v27, s70, v23
  v_mfma_f32_32x32x16_bf16 a[32:47], a[120:123], v[224:227], a[32:47]
  ds_read_b64_tr_b16 a[96:97], v16 offset:4096
  ds_read_b64_tr_b16 a[98:99], v16 offset:4608
  v_mul_f32 v24, v24, v112
  v_mul_f32 v25, v25, v113
  v_mul_f32 v26, v26, v114
  v_mfma_f32_32x32x16_bf16 a[48:63], a[124:127], v[224:227], a[48:63]
  ds_read_b64_tr_b16 a[100:101], v17 offset:4096
  ds_read_b64_tr_b16 a[102:103], v17 offset:4608
  v_mul_f32 v27, v27, v115
  v_exp_f32 v24, v24
  s_waitcnt lgkmcnt(8)
  v_mfma_f32_32x32x16_bf16 a[0:15], a[64:67], v[228:231], a[0:15]
  ds_read_b64_tr_b16 a[112:113], v14 offset:6144
  ds_read_b64_tr_b16 a[114:115], v14 offset:6656
  v_exp_f32 v25, v25
  v_exp_f32 v26, v26
  v_mfma_f32_32x32x16_bf16 a[16:31], a[68:71], v[228:231], a[16:31]
  ds_read_b64_tr_b16 a[116:117], v15 offset:6144
  ds_read_b64_tr_b16 a[118:119], v15 offset:6656
  v_exp_f32 v27, v27
  v_mul_f32 v120, v112, v120
  v_mfma_f32_32x32x16_bf16 a[32:47], a[72:75], v[228:231], a[32:47]
  ds_read_b64_tr_b16 a[120:121], v16 offset:6144
  ds_read_b64_tr_b16 a[122:123], v16 offset:6656
  v_mul_f32 v121, v113, v121
  v_mul_f32 v122, v114, v122
  v_mul_f32 v123, v115, v123
  v_mfma_f32_32x32x16_bf16 a[48:63], a[76:79], v[228:231], a[48:63]
  ds_read_b64_tr_b16 a[124:125], v17 offset:6144
  ds_read_b64_tr_b16 a[126:127], v17 offset:6656
  v_add_f32 v24, 1.0, v24
  v_add_f32 v25, 1.0, v25
  v_add_f32 v26, 1.0, v26
  s_waitcnt lgkmcnt(8)
  v_mfma_f32_32x32x16_bf16 a[0:15], a[88:91], v[232:235], a[0:15]
  ds_read_b64_tr_b16 a[64:65], v14 offset:8192
  ds_read_b64_tr_b16 a[66:67], v14 offset:8704
  v_add_f32 v27, 1.0, v27
  v_rcp_f32 v24, v24
  v_mfma_f32_32x32x16_bf16 a[16:31], a[92:95], v[232:235], a[16:31]
  ds_read_b64_tr_b16 a[68:69], v15 offset:8192
  ds_read_b64_tr_b16 a[70:71], v15 offset:8704
  v_rcp_f32 v25, v25
  v_rcp_f32 v26, v26
  v_mfma_f32_32x32x16_bf16 a[32:47], a[96:99], v[232:235], a[32:47]
  ds_read_b64_tr_b16 a[72:73], v16 offset:8192
  ds_read_b64_tr_b16 a[74:75], v16 offset:8704
  v_rcp_f32 v27, v27
  v_mul_f32 v112, v120, v24
  v_mfma_f32_32x32x16_bf16 a[48:63], a[100:103], v[232:235], a[48:63]
  ds_read_b64_tr_b16 a[76:77], v17 offset:8192
  ds_read_b64_tr_b16 a[78:79], v17 offset:8704
  v_mul_f32 v113, v121, v25
  v_mul_f32 v114, v122, v26
  v_mul_f32 v115, v123, v27
  s_waitcnt lgkmcnt(8)
  v_mfma_f32_32x32x16_bf16 a[0:15], a[112:115], v[236:239], a[0:15]
  ds_read_b64_tr_b16 a[88:89], v14 offset:10240
  ds_read_b64_tr_b16 a[90:91], v14 offset:10752
  v_mul_f32 v28, v116, v116
  v_mul_f32 v29, v117, v117
  v_mul_f32 v30, v118, v118
  v_mfma_f32_32x32x16_bf16 a[16:31], a[116:119], v[236:239], a[16:31]
  ds_read_b64_tr_b16 a[92:93], v15 offset:10240
  ds_read_b64_tr_b16 a[94:95], v15 offset:10752
  v_mul_f32 v31, v119, v119
  v_fma_f32 v28, v28, s70, v23
  v_fma_f32 v29, v29, s70, v23
  v_mfma_f32_32x32x16_bf16 a[32:47], a[120:123], v[236:239], a[32:47]
  ds_read_b64_tr_b16 a[96:97], v16 offset:10240
  ds_read_b64_tr_b16 a[98:99], v16 offset:10752
  v_fma_f32 v30, v30, s70, v23
  v_fma_f32 v31, v31, s70, v23
  v_mul_f32 v28, v28, v116
  v_mfma_f32_32x32x16_bf16 a[48:63], a[124:127], v[236:239], a[48:63]
  ds_read_b64_tr_b16 a[100:101], v17 offset:10240
  ds_read_b64_tr_b16 a[102:103], v17 offset:10752
  v_mul_f32 v29, v29, v117
  v_mul_f32 v30, v30, v118
  v_mul_f32 v31, v31, v119
  v_exp_f32 v28, v28
  s_waitcnt lgkmcnt(8)
  v_mfma_f32_32x32x16_bf16 a[0:15], a[64:67], v[240:243], a[0:15]
  ds_read_b64_tr_b16 a[112:113], v14 offset:12288
  ds_read_b64_tr_b16 a[114:115], v14 offset:12800
  v_exp_f32 v29, v29
  v_exp_f32 v30, v30
  v_mfma_f32_32x32x16_bf16 a[16:31], a[68:71], v[240:243], a[16:31]
  ds_read_b64_tr_b16 a[116:117], v15 offset:12288
  ds_read_b64_tr_b16 a[118:119], v15 offset:12800
  v_exp_f32 v31, v31
  v_mul_f32 v124, v116, v124
  v_mfma_f32_32x32x16_bf16 a[32:47], a[72:75], v[240:243], a[32:47]
  ds_read_b64_tr_b16 a[120:121], v16 offset:12288
  ds_read_b64_tr_b16 a[122:123], v16 offset:12800
  v_mul_f32 v125, v117, v125
  v_mul_f32 v126, v118, v126
  v_mul_f32 v127, v119, v127
  v_mfma_f32_32x32x16_bf16 a[48:63], a[76:79], v[240:243], a[48:63]
  ds_read_b64_tr_b16 a[124:125], v17 offset:12288
  ds_read_b64_tr_b16 a[126:127], v17 offset:12800
  v_add_f32 v28, 1.0, v28
  v_add_f32 v29, 1.0, v29
  v_add_f32 v30, 1.0, v30
  v_add_f32 v31, 1.0, v31
  s_waitcnt lgkmcnt(8)
  v_mfma_f32_32x32x16_bf16 a[0:15], a[88:91], v[244:247], a[0:15]
  ds_read_b64_tr_b16 a[64:65], v14 offset:14336
  ds_read_b64_tr_b16 a[66:67], v14 offset:14848
  v_rcp_f32 v28, v28
  v_rcp_f32 v29, v29
  v_mfma_f32_32x32x16_bf16 a[16:31], a[92:95], v[244:247], a[16:31]
  ds_read_b64_tr_b16 a[68:69], v15 offset:14336
  ds_read_b64_tr_b16 a[70:71], v15 offset:14848
  v_rcp_f32 v30, v30
  v_rcp_f32 v31, v31
  v_mfma_f32_32x32x16_bf16 a[32:47], a[96:99], v[244:247], a[32:47]
  ds_read_b64_tr_b16 a[72:73], v16 offset:14336
  ds_read_b64_tr_b16 a[74:75], v16 offset:14848
  v_mul_f32 v116, v124, v28
  v_mul_f32 v117, v125, v29
  v_mul_f32 v118, v126, v30
  v_mfma_f32_32x32x16_bf16 a[48:63], a[100:103], v[244:247], a[48:63]
  ds_read_b64_tr_b16 a[76:77], v17 offset:14336
  ds_read_b64_tr_b16 a[78:79], v17 offset:14848
  v_mul_f32 v119, v127, v31
  v_cvt_pk_bf16_f32 v112, v112, v113
  v_cvt_pk_bf16_f32 v113, v114, v115
  s_waitcnt lgkmcnt(8)
  v_mfma_f32_32x32x16_bf16 a[0:15], a[112:115], v[248:251], a[0:15]
  v_cvt_pk_bf16_f32 v114, v116, v117
  v_mfma_f32_32x32x16_bf16 a[16:31], a[116:119], v[248:251], a[16:31]
  v_cvt_pk_bf16_f32 v115, v118, v119
  v_mfma_f32_32x32x16_bf16 a[32:47], a[120:123], v[248:251], a[32:47]
  s_add_u32 s75, s78, 2048
  v_mfma_f32_32x32x16_bf16 a[48:63], a[124:127], v[248:251], a[48:63]
  buffer_load_dword v2, v3, s[16:19], s91 offen sc1
  buffer_store_dwordx4 v[112:115], v21, s[16:19], s75 offen sc0 sc1
  s_waitcnt lgkmcnt(0)
  v_mfma_f32_32x32x16_bf16 a[0:15], a[64:67], v[252:255], a[0:15]
  v_mfma_f32_32x32x16_bf16 a[16:31], a[68:71], v[252:255], a[16:31]
  v_mfma_f32_32x32x16_bf16 a[32:47], a[72:75], v[252:255], a[32:47]
  v_mfma_f32_32x32x16_bf16 a[48:63], a[76:79], v[252:255], a[48:63]
  s_barrier
  s_lshl_b32 s68, s80, 16
  s_add_u32 s68, s68, 2097152
  s_mul_i32 s69, s80, 73728
  s_add_u32 s69, s69, 4194304
  s_mul_i32 s85, s56, 12288
  s_add_u32 s86, s85, 24576
  s_add_u32 s85, s85, 16384
  s_add_u32 s93, s85, s68
  s_add_u32 s94, s85, 0
  s_add_u32 s100, s86, s69
  s_add_u32 s101, s86, 65536
  s_lshl_b32 s84, s56, 17
  s_lshl_b32 s74, s83, 7
  s_add_u32 s84, s84, s74
  v_accvgpr_read_b32 v32, a0
  v_accvgpr_read_b32 v33, a1
  v_accvgpr_read_b32 v34, a2
  v_accvgpr_read_b32 v35, a3
  v_accvgpr_read_b32 v36, a4
  v_accvgpr_read_b32 v37, a5
  v_accvgpr_read_b32 v38, a6
  v_accvgpr_read_b32 v39, a7
  v_accvgpr_read_b32 v40, a8
  v_accvgpr_read_b32 v41, a9
  v_accvgpr_read_b32 v42, a10
  v_accvgpr_read_b32 v43, a11
  v_accvgpr_read_b32 v44, a12
  v_accvgpr_read_b32 v45, a13
  v_accvgpr_read_b32 v46, a14
  v_accvgpr_read_b32 v47, a15
  v_mul_f32 v24, v32, v32
  v_mul_f32 v25, v33, v33
  v_mul_f32 v26, v34, v34
  v_mul_f32 v27, v35, v35
  v_fma_f32 v24, v24, s70, v23
  v_fma_f32 v25, v25, s70, v23
  v_fma_f32 v26, v26, s70, v23
  v_fma_f32 v27, v27, s70, v23
  v_mul_f32 v24, v24, v32
  v_mul_f32 v25, v25, v33
  v_mul_f32 v26, v26, v34
  v_mul_f32 v27, v27, v35
  v_exp_f32 v24, v24
  v_exp_f32 v25, v25
  v_exp_f32 v26, v26
  v_exp_f32 v27, v27
  v_mul_f32 v40, v32, v40
  v_mul_f32 v41, v33, v41
  v_mul_f32 v42, v34, v42
  v_mul_f32 v43, v35, v43
  v_add_f32 v24, 1.0, v24
  v_add_f32 v25, 1.0, v25
  v_add_f32 v26, 1.0, v26
  v_add_f32 v27, 1.0, v27
  v_rcp_f32 v24, v24
  v_rcp_f32 v25, v25
  v_rcp_f32 v26, v26
  v_rcp_f32 v27, v27
  v_mul_f32 v32, v40, v24
  v_mul_f32 v33, v41, v25
  v_mul_f32 v34, v42, v26
  v_mul_f32 v35, v43, v27
  v_mul_f32 v28, v36, v36
  v_mul_f32 v29, v37, v37
  v_mul_f32 v30, v38, v38
  v_mul_f32 v31, v39, v39
  v_fma_f32 v28, v28, s70, v23
  v_fma_f32 v29, v29, s70, v23
  v_fma_f32 v30, v30, s70, v23
  v_fma_f32 v31, v31, s70, v23
  v_mul_f32 v28, v28, v36
  v_mul_f32 v29, v29, v37
  v_mul_f32 v30, v30, v38
  v_mul_f32 v31, v31, v39
  v_exp_f32 v28, v28
  v_exp_f32 v29, v29
  v_exp_f32 v30, v30
  v_exp_f32 v31, v31
  v_mul_f32 v44, v36, v44
  v_mul_f32 v45, v37, v45
  v_mul_f32 v46, v38, v46
  v_mul_f32 v47, v39, v47
  v_add_f32 v28, 1.0, v28
  v_add_f32 v29, 1.0, v29
  v_add_f32 v30, 1.0, v30
  v_add_f32 v31, 1.0, v31
  v_rcp_f32 v28, v28
  v_rcp_f32 v29, v29
  v_rcp_f32 v30, v30
  v_rcp_f32 v31, v31
  v_mul_f32 v36, v44, v28
  v_mul_f32 v37, v45, v29
  v_mul_f32 v38, v46, v30
  v_mul_f32 v39, v47, v31
  v_cvt_pk_bf16_f32 v32, v32, v33
  v_cvt_pk_bf16_f32 v33, v34, v35
  v_cvt_pk_bf16_f32 v34, v36, v37
  v_cvt_pk_bf16_f32 v35, v38, v39
  s_add_u32 s75, s3, 0
  buffer_store_dwordx4 v[32:35], v21, s[16:19], s75 offen sc0 sc1
  v_accvgpr_read_b32 v48, a16
  v_accvgpr_read_b32 v49, a17
  v_accvgpr_read_b32 v50, a18
  v_accvgpr_read_b32 v51, a19
  v_accvgpr_read_b32 v52, a20
  v_accvgpr_read_b32 v53, a21
  v_accvgpr_read_b32 v54, a22
  v_accvgpr_read_b32 v55, a23
  v_accvgpr_read_b32 v56, a24
  v_accvgpr_read_b32 v57, a25
  v_accvgpr_read_b32 v58, a26
  v_accvgpr_read_b32 v59, a27
  v_accvgpr_read_b32 v60, a28
  v_accvgpr_read_b32 v61, a29
  v_accvgpr_read_b32 v62, a30
  v_accvgpr_read_b32 v63, a31
  v_mul_f32 v24, v48, v48
  v_mul_f32 v25, v49, v49
  v_mul_f32 v26, v50, v50
  v_mul_f32 v27, v51, v51
  v_fma_f32 v24, v24, s70, v23
  v_fma_f32 v25, v25, s70, v23
  v_fma_f32 v26, v26, s70, v23
  v_fma_f32 v27, v27, s70, v23
  v_mul_f32 v24, v24, v48
  v_mul_f32 v25, v25, v49
  v_mul_f32 v26, v26, v50
  v_mul_f32 v27, v27, v51
  v_exp_f32 v24, v24
  v_exp_f32 v25, v25
  v_exp_f32 v26, v26
  v_exp_f32 v27, v27
  v_mul_f32 v56, v48, v56
  v_mul_f32 v57, v49, v57
  v_mul_f32 v58, v50, v58
  v_mul_f32 v59, v51, v59
  v_add_f32 v24, 1.0, v24
  v_add_f32 v25, 1.0, v25
  v_add_f32 v26, 1.0, v26
  v_add_f32 v27, 1.0, v27
  v_rcp_f32 v24, v24
  v_rcp_f32 v25, v25
  v_rcp_f32 v26, v26
  v_rcp_f32 v27, v27
  v_mul_f32 v48, v56, v24
  v_mul_f32 v49, v57, v25
  v_mul_f32 v50, v58, v26
  v_mul_f32 v51, v59, v27
  v_mul_f32 v28, v52, v52
  v_mul_f32 v29, v53, v53
  v_mul_f32 v30, v54, v54
  v_mul_f32 v31, v55, v55
  v_fma_f32 v28, v28, s70, v23
  v_fma_f32 v29, v29, s70, v23
  v_fma_f32 v30, v30, s70, v23
  v_fma_f32 v31, v31, s70, v23
  v_mul_f32 v28, v28, v52
  v_mul_f32 v29, v29, v53
  v_mul_f32 v30, v30, v54
  v_mul_f32 v31, v31, v55
  v_exp_f32 v28, v28
  v_exp_f32 v29, v29
  v_exp_f32 v30, v30
  v_exp_f32 v31, v31
  v_mul_f32 v60, v52, v60
  v_mul_f32 v61, v53, v61
  v_mul_f32 v62, v54, v62
  v_mul_f32 v63, v55, v63
  v_add_f32 v28, 1.0, v28
  v_add_f32 v29, 1.0, v29
  v_add_f32 v30, 1.0, v30
  v_add_f32 v31, 1.0, v31
  v_rcp_f32 v28, v28
  v_rcp_f32 v29, v29
  v_rcp_f32 v30, v30
  v_rcp_f32 v31, v31
  v_mul_f32 v52, v60, v28
  v_mul_f32 v53, v61, v29
  v_mul_f32 v54, v62, v30
  v_mul_f32 v55, v63, v31
  v_cvt_pk_bf16_f32 v48, v48, v49
  v_cvt_pk_bf16_f32 v49, v50, v51
  v_cvt_pk_bf16_f32 v50, v52, v53
  v_cvt_pk_bf16_f32 v51, v54, v55
  s_add_u32 s75, s3, 1024
  buffer_store_dwordx4 v[48:51], v21, s[16:19], s75 offen sc0 sc1
  s_waitcnt vmcnt(3)
  v_readfirstlane_b32 s88, v2
  s_nop 0
  s_cmp_ge_u32 s88, 32
  s_cbranch_scc1 L_polled_6
  s_mov_b32 s89, 0
L_poll_5:
  s_sleep 2
  buffer_load_dword v2, v3, s[16:19], s91 offen sc1
  s_add_u32 s89, s89, 1
  s_waitcnt vmcnt(0)
  v_readfirstlane_b32 s88, v2
  s_cmp_gt_u32 s89, 200000
  s_cbranch_scc1 L_polled_6
  s_cmp_ge_u32 s88, 32
  s_cbranch_scc0 L_poll_5
L_polled_6:
  s_lshl_b32 s85, s56, 12
  s_mul_i32 s86, s56, 6144
  s_lshl_b32 s72, s80, 16
  s_lshl_b32 s75, s81, 13
  s_add_u32 s72, s72, s75
  s_lshl_b32 s75, s56, 11
  s_add_u32 s72, s72, s75
  s_add_u32 s73, s85, 0
  s_add_u32 s74, s73, s68
  s_add_u32 m0, s73, 0
  v_accvgpr_write_b32 a92, 0
  buffer_load_dwordx4 v21, s[16:19], s74 offen offset:0 sc1 lds
  v_accvgpr_write_b32 a93, 0
  v_accvgpr_write_b32 a94, 0
  v_accvgpr_write_b32 a95, 0
  v_accvgpr_read_b32 v64, a32
  v_accvgpr_read_b32 v65, a33
  v_accvgpr_read_b32 v66, a34
  buffer_load_dwordx4 v21, s[16:19], s74 offen offset:1024 sc1 lds
  v_accvgpr_read_b32 v67, a35
  v_accvgpr_read_b32 v68, a36
  v_accvgpr_read_b32 v69, a37
  v_accvgpr_read_b32 v70, a38
  v_accvgpr_read_b32 v71, a39
  v_accvgpr_read_b32 v72, a40
  buffer_load_dwordx4 v21, s[16:19], s74 offen offset:2048 sc1 lds
  v_accvgpr_read_b32 v73, a41
  v_accvgpr_read_b32 v74, a42
  v_accvgpr_read_b32 v75, a43
  v_accvgpr_read_b32 v76, a44
  v_accvgpr_read_b32 v77, a45
  v_accvgpr_read_b32 v78, a46
  buffer_load_dwordx4 v21, s[16:19], s74 offen offset:3072 sc1 lds
  v_accvgpr_read_b32 v79, a47
  v_mul_f32 v24, v64, v64
  v_mul_f32 v25, v65, v65
  v_mul_f32 v26, v66, v66
  v_mul_f32 v27, v67, v67
  s_add_u32 s73, s86, 0
  s_add_u32 s74, s73, s69
  s_add_u32 m0, s73, 65536
  v_fma_f32 v24, v24, s70, v23
  buffer_load_dwordx4 v21, s[16:19], s74 offen offset:0 sc1 lds
  v_fma_f32 v25, v25, s70, v23
  v_fma_f32 v26, v26, s70, v23
  v_fma_f32 v27, v27, s70, v23
  v_mul_f32 v24, v24, v64
  v_mul_f32 v25, v25, v65
  v_mul_f32 v26, v26, v66
  buffer_load_dwordx4 v21, s[16:19], s74 offen offset:1024 sc1 lds
  v_mul_f32 v27, v27, v67
  v_exp_f32 v24, v24
  v_exp_f32 v25, v25
  v_exp_f32 v26, v26
  v_exp_f32 v27, v27
  v_mul_f32 v72, v64, v72
  buffer_load_dwordx4 v21, s[16:19], s74 offen offset:2048 sc1 lds
  v_mul_f32 v73, v65, v73
  v_mul_f32 v74, v66, v74
  v_mul_f32 v75, v67, v75
  v_add_f32 v24, 1.0, v24
  v_add_f32 v25, 1.0, v25
  v_add_f32 v26, 1.0, v26
  buffer_load_dwordx4 v21, s[16:19], s74 offen offset:3072 sc1 lds
  v_add_f32 v27, 1.0, v27
  v_rcp_f32 v24, v24
  v_rcp_f32 v25, v25
  v_rcp_f32 v26, v26
  v_rcp_f32 v27, v27
  s_add_u32 s73, s86, 4096
  s_add_u32 s74, s73, s69
  s_add_u32 m0, s73, 65536
  v_mul_f32 v64, v72, v24
  buffer_load_dwordx4 v21, s[16:19], s74 offen offset:0 sc1 lds
  v_mul_f32 v65, v73, v25
  v_mul_f32 v66, v74, v26
  v_mul_f32 v67, v75, v27
  v_mul_f32 v28, v68, v68
  v_mul_f32 v29, v69, v69
  v_mul_f32 v30, v70, v70
  buffer_load_dwordx4 v21, s[16:19], s74 offen offset:1024 sc1 lds
  v_mul_f32 v31, v71, v71
  v_fma_f32 v28, v28, s70, v23
  v_fma_f32 v29, v29, s70, v23
  v_fma_f32 v30, v30, s70, v23
  v_fma_f32 v31, v31, s70, v23
  v_mul_f32 v28, v28, v68
  buffer_load_dwordx4 a[64:67], v21, s[16:19], s72 offen sc1
  v_mul_f32 v29, v29, v69
  v_mul_f32 v30, v30, v70
  v_mul_f32 v31, v31, v71
  v_exp_f32 v28, v28
  v_exp_f32 v29, v29
  v_exp_f32 v30, v30
  buffer_load_dwordx4 a[68:71], v21, s[16:19], s72 offen offset:1024 sc1
  v_exp_f32 v31, v31
  v_mul_f32 v76, v68, v76
  v_mul_f32 v77, v69, v77
  v_mul_f32 v78, v70, v78
  v_mul_f32 v79, v71, v79
  v_add_f32 v28, 1.0, v28
  v_add_f32 v29, 1.0, v29
  v_add_f32 v30, 1.0, v30
  v_add_f32 v31, 1.0, v31
  v_rcp_f32 v28, v28
  v_rcp_f32 v29, v29
  v_mfma_f32_32x32x16_bf16 a[208:223], a[92:95], a[92:95], 0
  v_rcp_f32 v30, v30
  v_rcp_f32 v31, v31
  v_mul_f32 v68, v76, v28
  v_mul_f32 v69, v77, v29
  v_mul_f32 v70, v78, v30
  v_mul_f32 v71, v79, v31
  v_cvt_pk_bf16_f32 v64, v64, v65
  v_cvt_pk_bf16_f32 v65, v66, v67
  v_cvt_pk_bf16_f32 v66, v68, v69
  v_cvt_pk_bf16_f32 v67, v70, v71
  s_add_u32 s75, s3, 2048
  buffer_store_dwordx4 v[64:67], v21, s[16:19], s75 offen sc0 sc1
  v_mfma_f32_32x32x16_bf16 a[224:239], a[92:95], a[92:95], 0
  v_accvgpr_read_b32 v80, a48
  v_accvgpr_read_b32 v81, a49
  v_accvgpr_read_b32 v82, a50
  v_accvgpr_read_b32 v83, a51
  v_accvgpr_read_b32 v84, a52
  v_accvgpr_read_b32 v85, a53
  v_accvgpr_read_b32 v86, a54
  v_accvgpr_read_b32 v87, a55
  v_accvgpr_read_b32 v88, a56
  v_accvgpr_read_b32 v89, a57
  v_accvgpr_read_b32 v90, a58
  v_accvgpr_read_b32 v91, a59
  v_mfma_f32_32x32x16_bf16 a[144:159], a[92:95], a[92:95], 0
  v_accvgpr_read_b32 v92, a60
  v_accvgpr_read_b32 v93, a61
  v_accvgpr_read_b32 v94, a62
  v_accvgpr_read_b32 v95, a63
  v_mul_f32 v24, v80, v80
  v_mul_f32 v25, v81, v81
  v_mul_f32 v26, v82, v82
  v_mul_f32 v27, v83, v83
  v_fma_f32 v24, v24, s70, v23
  v_fma_f32 v25, v25, s70, v23
  v_fma_f32 v26, v26, s70, v23
  v_fma_f32 v27, v27, s70, v23
  v_mfma_f32_32x32x16_bf16 a[160:175], a[92:95], a[92:95], 0
  v_mul_f32 v24, v24, v80
  v_mul_f32 v25, v25, v81
  v_mul_f32 v26, v26, v82
  v_mul_f32 v27, v27, v83
  v_exp_f32 v24, v24
  v_exp_f32 v25, v25
  v_exp_f32 v26, v26
  v_exp_f32 v27, v27
  v_mul_f32 v88, v80, v88
  v_mul_f32 v89, v81, v89
  v_mul_f32 v90, v82, v90
  v_mul_f32 v91, v83, v91
  v_mfma_f32_32x32x16_bf16 a[176:191], a[92:95], a[92:95], 0
  v_add_f32 v24, 1.0, v24
  v_add_f32 v25, 1.0, v25
  v_add_f32 v26, 1.0, v26
  v_add_f32 v27, 1.0, v27
  v_rcp_f32 v24, v24
  v_rcp_f32 v25, v25
  v_rcp_f32 v26, v26
  v_rcp_f32 v27, v27
  v_mul_f32 v80, v88, v24
  v_mul_f32 v81, v89, v25
  v_mul_f32 v82, v90, v26
  v_mul_f32 v83, v91, v27
  v_mfma_f32_32x32x16_bf16 a[192:207], a[92:95], a[92:95], 0
  v_mul_f32 v28, v84, v84
  v_mul_f32 v29, v85, v85
  v_mul_f32 v30, v86, v86
  v_mul_f32 v31, v87, v87
  v_fma_f32 v28, v28, s70, v23
  v_fma_f32 v29, v29, s70, v23
  v_fma_f32 v30, v30, s70, v23
  v_fma_f32 v31, v31, s70, v23
  v_mul_f32 v28, v28, v84
  v_mul_f32 v29, v29, v85
  v_mul_f32 v30, v30, v86
  v_mul_f32 v31, v31, v87
  v_mfma_f32_32x32x16_bf16 a[240:255], a[92:95], a[92:95], 0
  v_exp_f32 v28, v28
  v_exp_f32 v29, v29
  v_exp_f32 v30, v30
  v_exp_f32 v31, v31
  v_mul_f32 v92, v84, v92
  v_mul_f32 v93, v85, v93
  v_mul_f32 v94, v86, v94
  v_mul_f32 v95, v87, v95
  v_add_f32 v28, 1.0, v28
  v_add_f32 v29, 1.0, v29
  v_add_f32 v30, 1.0, v30
  v_add_f32 v31, 1.0, v31
  v_rcp_f32 v28, v28
  v_rcp_f32 v29, v29
  v_rcp_f32 v30, v30
  v_rcp_f32 v31, v31
  v_mul_f32 v84, v92, v28
  v_mul_f32 v85, v93, v29
  v_mul_f32 v86, v94, v30
  v_mul_f32 v87, v95, v31
  v_cvt_pk_bf16_f32 v80, v80, v81
  v_cvt_pk_bf16_f32 v81, v82, v83
  v_cvt_pk_bf16_f32 v82, v84, v85
  v_cvt_pk_bf16_f32 v83, v86, v87
  s_add_u32 s75, s3, 3072
  buffer_store_dwordx4 v[80:83], v21, s[16:19], s75 offen sc0 sc1
  s_and_b32 s72, s56, 1
  s_lshl_b32 s72, s72, 5
  s_lshl_b32 s73, s82, 6
  s_add_u32 s72, s72, s73
  s_lshl_b32 s72, s72, 10
  s_lshr_b32 s73, s56, 1
  s_lshl_b32 s73, s73, 6
  s_lshl_b32 s74, s83, 7
  s_add_u32 s72, s72, s73
  s_add_u32 s95, s72, s74
  v_and_b32 v24, 31, v1
  v_lshlrev_b32 v24, 10, v24
  v_lshrrev_b32 v25, 5, v1
  v_lshl_add_u32 v11, v25, 3, v24
  v_lshl_add_u32 v12, v25, 4, v24
  buffer_load_dwordx2 v[112:113], v11, s[4:7], s95 offen offset:0
  buffer_load_dwordx2 v[114:115], v11, s[4:7], s95 offen offset:16
  buffer_load_dwordx2 v[116:117], v11, s[4:7], s95 offen offset:32
  buffer_load_dwordx2 v[118:119], v11, s[4:7], s95 offen offset:48
  s_mov_b32 s66, s92
  s_mul_i32 s72, s82, 229376
  s_mul_i32 s63, s56, 28672
  s_add_u32 s72, s72, s63
  s_add_u32 s63, s72, 7340032
  s_add_u32 s64, s63, 114688
  s_mul_i32 s72, s56, 458752
  s_lshl_b32 s65, s83, 7
  s_add_u32 s65, s72, s65
  v_add_u32 v14, 114688, v21
  v_mov_b32 v108, 0
  v_mov_b32 v109, 0
  v_mov_b32 v110, 0
  v_mov_b32 v111, 0
  s_waitcnt vmcnt(6)
  s_barrier
  ds_read_b128 a[80:83], v0 offset:0
  ds_read_b128 a[88:91], v0 offset:576
  ds_read_b128 a[72:75], v10 offset:0
  s_waitcnt lgkmcnt(0)
  v_mfma_f32_32x32x16_bf16 v[32:47], a[72:75], a[64:67], 0
  v_mfma_f32_32x32x16_bf16 v[48:63], a[72:75], a[68:71], 0
  s_nop 10
  v_max3_f32 v24, v32, v33, v34
  v_max3_f32 v24, v24, v35, v36
  v_max3_f32 v24, v24, v37, v38
  v_max3_f32 v24, v24, v39, v40
  v_max3_f32 v24, v24, v41, v42
  v_max3_f32 v24, v24, v43, v44
  v_max3_f32 v24, v24, v45, v46
  v_max_f32 v24, v24, v47
  v_mov_b32 v25, v24
  v_max3_f32 v26, v48, v49, v50
  v_max3_f32 v26, v26, v51, v52
  v_max3_f32 v26, v26, v53, v54
  v_max3_f32 v26, v26, v55, v56
  v_max3_f32 v26, v26, v57, v58
  v_max3_f32 v26, v26, v59, v60
  v_max3_f32 v26, v26, v61, v62
  v_max_f32 v26, v26, v63
  v_mov_b32 v27, v26
  v_permlane32_swap_b32 v24, v25
  s_nop 0
  v_permlane32_swap_b32 v26, v27
  v_max_f32 v24, v24, v25
  v_add_f32 v24, 0x42c00000, v24
  v_max_f32 v26, v26, v27
  v_add_f32 v26, 0x42c00000, v26
  v_sub_f32 v64, 0, v24
  v_sub_f32 v65, 0, v24
  v_sub_f32 v66, 0, v24
  v_sub_f32 v67, 0, v24
  v_sub_f32 v68, 0, v24
  v_sub_f32 v69, 0, v24
  v_sub_f32 v70, 0, v24
  v_sub_f32 v71, 0, v24
  v_sub_f32 v72, 0, v24
  v_sub_f32 v73, 0, v24
  v_sub_f32 v74, 0, v24
  v_sub_f32 v75, 0, v24
  v_sub_f32 v76, 0, v24
  v_sub_f32 v77, 0, v24
  v_sub_f32 v78, 0, v24
  v_sub_f32 v79, 0, v24
  s_nop 1
  v_mfma_f32_32x32x16_bf16 v[32:47], a[72:75], a[64:67], v[64:79]
  v_sub_f32 v80, 0, v26
  v_sub_f32 v81, 0, v26
  v_sub_f32 v82, 0, v26
  v_sub_f32 v83, 0, v26
  v_sub_f32 v84, 0, v26
  v_sub_f32 v85, 0, v26
  v_sub_f32 v86, 0, v26
  v_sub_f32 v87, 0, v26
  v_sub_f32 v88, 0, v26
  v_sub_f32 v89, 0, v26
  v_sub_f32 v90, 0, v26
  v_sub_f32 v91, 0, v26
  v_sub_f32 v92, 0, v26
  v_sub_f32 v93, 0, v26
  v_sub_f32 v94, 0, v26
  v_sub_f32 v95, 0, v26
  s_mov_b32 s67, 0
L_att0:
  s_mov_b32 m0, s94
  v_mfma_f32_32x32x16_bf16 v[48:63], a[72:75], a[68:71], v[80:95]
  buffer_load_dwordx4 v21, s[16:19], s93 offen offset:0 sc1 lds
  v_exp_f32 v32, v32
  v_exp_f32 v33, v33
  v_exp_f32 v34, v34
  v_mfma_f32_32x32x16_bf16 a[224:239], a[92:95], v[108:111], a[224:239]
  ds_read_b128 a[84:87], v0 offset:1152
  ds_read_b128 a[92:95], v0 offset:1728
  ds_read_b128 a[76:79], v10 offset:1024
  v_exp_f32 v35, v35
  v_exp_f32 v36, v36
  v_exp_f32 v37, v37
  v_exp_f32 v38, v38
  v_exp_f32 v39, v39
  v_cvt_pk_bf16_f32 v96, v32, v33
  v_cvt_pk_bf16_f32 v97, v34, v35
  v_cvt_pk_bf16_f32 v98, v36, v37
  v_cvt_pk_bf16_f32 v99, v38, v39
  v_exp_f32 v40, v40
  v_exp_f32 v41, v41
  v_mfma_f32_32x32x16_bf16 a[208:223], a[80:83], v[96:99], a[208:223]
  v_exp_f32 v42, v42
  v_exp_f32 v43, v43
  v_exp_f32 v44, v44
  v_exp_f32 v45, v45
  v_exp_f32 v46, v46
  v_exp_f32 v47, v47
  v_cvt_pk_bf16_f32 v100, v40, v41
  v_cvt_pk_bf16_f32 v101, v42, v43
  v_cvt_pk_bf16_f32 v102, v44, v45
  v_cvt_pk_bf16_f32 v103, v46, v47
  s_waitcnt lgkmcnt(0)
  v_mfma_f32_32x32x16_bf16 v[32:47], a[76:79], a[64:67], v[64:79]
  buffer_load_dwordx4 v21, s[16:19], s93 offen offset:1024 sc1 lds
  v_exp_f32 v48, v48
  v_exp_f32 v49, v49
  v_exp_f32 v50, v50
  v_mfma_f32_32x32x16_bf16 a[208:223], a[88:91], v[100:103], a[208:223]
  v_exp_f32 v51, v51
  v_exp_f32 v52, v52
  v_exp_f32 v53, v53
  v_exp_f32 v54, v54
  v_exp_f32 v55, v55
  v_cvt_pk_bf16_f32 v104, v48, v49
  v_cvt_pk_bf16_f32 v105, v50, v51
  v_cvt_pk_bf16_f32 v106, v52, v53
  v_cvt_pk_bf16_f32 v107, v54, v55
  v_exp_f32 v56, v56
  v_exp_f32 v57, v57
  v_mfma_f32_32x32x16_bf16 a[224:239], a[80:83], v[104:107], a[224:239]
  buffer_load_dwordx4 v21, s[16:19], s93 offen offset:2048 sc1 lds
  s_add_u32 s93, s93, 3072
  s_add_u32 s94, s94, 3072
  v_exp_f32 v58, v58
  v_exp_f32 v59, v59
  v_exp_f32 v60, v60
  v_exp_f32 v61, v61
  v_exp_f32 v62, v62
  v_exp_f32 v63, v63
  v_cvt_pk_bf16_f32 v108, v56, v57
  v_cvt_pk_bf16_f32 v109, v58, v59
  v_cvt_pk_bf16_f32 v110, v60, v61
  v_cvt_pk_bf16_f32 v111, v62, v63
  s_mov_b32 m0, s94
  v_mfma_f32_32x32x16_bf16 v[48:63], a[76:79], a[68:71], v[80:95]
  buffer_load_dwordx4 v21, s[16:19], s93 offen offset:0 sc1 lds
  v_exp_f32 v32, v32
  v_exp_f32 v33, v33
  v_exp_f32 v34, v34
  v_mfma_f32_32x32x16_bf16 a[224:239], a[88:91], v[108:111], a[224:239]
  ds_read_b128 a[80:83], v0 offset:2304
  ds_read_b128 a[88:91], v0 offset:2880
  ds_read_b128 a[72:75], v10 offset:2048
  v_exp_f32 v35, v35
  v_exp_f32 v36, v36
  v_exp_f32 v37, v37
  v_exp_f32 v38, v38
  v_exp_f32 v39, v39
  v_cvt_pk_bf16_f32 v96, v32, v33
  v_cvt_pk_bf16_f32 v97, v34, v35
  v_cvt_pk_bf16_f32 v98, v36, v37
  v_cvt_pk_bf16_f32 v99, v38, v39
  v_exp_f32 v40, v40
  v_exp_f32 v41, v41
  v_mfma_f32_32x32x16_bf16 a[208:223], a[84:87], v[96:99], a[208:223]
  v_exp_f32 v42, v42
  v_exp_f32 v43, v43
  v_exp_f32 v44, v44
  v_exp_f32 v45, v45
  v_exp_f32 v46, v46
  v_exp_f32 v47, v47
  v_cvt_pk_bf16_f32 v100, v40, v41
  v_cvt_pk_bf16_f32 v101, v42, v43
  v_cvt_pk_bf16_f32 v102, v44, v45
  v_cvt_pk_bf16_f32 v103, v46, v47
  s_waitcnt lgkmcnt(0)
  v_mfma_f32_32x32x16_bf16 v[32:47], a[72:75], a[64:67], v[64:79]
  buffer_load_dwordx4 v21, s[16:19], s93 offen offset:1024 sc1 lds
  v_exp_f32 v48, v48
  v_exp_f32 v49, v49
  v_exp_f32 v50, v50
  v_mfma_f32_32x32x16_bf16 a[208:223], a[92:95], v[100:103], a[208:223]
  v_exp_f32 v51, v51
  v_exp_f32 v52, v52
  v_exp_f32 v53, v53
  v_exp_f32 v54, v54
  v_exp_f32 v55, v55
  v_cvt_pk_bf16_f32 v104, v48, v49
  v_cvt_pk_bf16_f32 v105, v50, v51
  v_cvt_pk_bf16_f32 v106, v52, v53
  v_cvt_pk_bf16_f32 v107, v54, v55
  v_exp_f32 v56, v56
  v_exp_f32 v57, v57
  v_mfma_f32_32x32x16_bf16 a[224:239], a[84:87], v[104:107], a[224:239]
  buffer_load_dwordx4 v21, s[16:19], s93 offen offset:2048 sc1 lds
  s_add_u32 s93, s93, 3072
  s_add_u32 s94, s94, 3072
  v_exp_f32 v58, v58
  v_exp_f32 v59, v59
  v_exp_f32 v60, v60
  v_exp_f32 v61, v61
  v_exp_f32 v62, v62
  v_exp_f32 v63, v63
  v_cvt_pk_bf16_f32 v108, v56, v57
  v_cvt_pk_bf16_f32 v109, v58, v59
  v_cvt_pk_bf16_f32 v110, v60, v61
  v_cvt_pk_bf16_f32 v111, v62, v63
  s_mov_b32 m0, s94
  v_mfma_f32_32x32x16_bf16 v[48:63], a[72:75], a[68:71], v[80:95]
  buffer_load_dwordx4 v21, s[16:19], s93 offen offset:0 sc1 lds
  v_exp_f32 v32, v32
  v_exp_f32 v33, v33
  v_exp_f32 v34, v34
  v_mfma_f32_32x32x16_bf16 a[224:239], a[92:95], v[108:111], a[224:239]
  ds_read_b128 a[84:87], v0 offset:3456
  ds_read_b128 a[92:95], v0 offset:4032
  ds_read_b128 a[76:79], v10 offset:3072
  v_exp_f32 v35, v35
  v_exp_f32 v36, v36
  v_exp_f32 v37, v37
  v_exp_f32 v38, v38
  v_exp_f32 v39, v39
  v_cvt_pk_bf16_f32 v96, v32, v33
  v_cvt_pk_bf16_f32 v97, v34, v35
  v_cvt_pk_bf16_f32 v98, v36, v37
  v_cvt_pk_bf16_f32 v99, v38, v39
  v_exp_f32 v40, v40
  v_exp_f32 v41, v41
  v_mfma_f32_32x32x16_bf16 a[208:223], a[80:83], v[96:99], a[208:223]
  s_waitcnt vmcnt(12)
  buffer_load_dword v2, v3, s[16:19], s58 offen sc1
  v_exp_f32 v42, v42
  v_exp_f32 v43, v43
  v_exp_f32 v44, v44
  v_exp_f32 v45, v45
  v_exp_f32 v46, v46
  v_exp_f32 v47, v47
  v_cvt_pk_bf16_f32 v100, v40, v41
  v_cvt_pk_bf16_f32 v101, v42, v43
  v_cvt_pk_bf16_f32 v102, v44, v45
  v_cvt_pk_bf16_f32 v103, v46, v47
  s_waitcnt lgkmcnt(0)
  v_mfma_f32_32x32x16_bf16 v[32:47], a[76:79], a[64:67], v[64:79]
  buffer_load_dwordx4 v21, s[16:19], s93 offen offset:1024 sc1 lds
  v_exp_f32 v48, v48
  v_exp_f32 v49, v49
  v_exp_f32 v50, v50
  v_mfma_f32_32x32x16_bf16 a[208:223], a[88:91], v[100:103], a[208:223]
  v_exp_f32 v51, v51
  v_exp_f32 v52, v52
  v_exp_f32 v53, v53
  v_exp_f32 v54, v54
  v_exp_f32 v55, v55
  v_cvt_pk_bf16_f32 v104, v48, v49
  v_cvt_pk_bf16_f32 v105, v50, v51
  v_cvt_pk_bf16_f32 v106, v52, v53
  v_cvt_pk_bf16_f32 v107, v54, v55
  v_exp_f32 v56, v56
  v_exp_f32 v57, v57
  v_mfma_f32_32x32x16_bf16 a[224:239], a[80:83], v[104:107], a[224:239]
  buffer_load_dwordx4 v21, s[16:19], s93 offen offset:2048 sc1 lds
  s_add_u32 s93, s93, 3072
  s_add_u32 s94, s94, 3072
  v_exp_f32 v58, v58
  v_exp_f32 v59, v59
  v_exp_f32 v60, v60
  v_exp_f32 v61, v61
  v_exp_f32 v62, v62
  v_exp_f32 v63, v63
  v_cvt_pk_bf16_f32 v108, v56, v57
  v_cvt_pk_bf16_f32 v109, v58, v59
  v_cvt_pk_bf16_f32 v110, v60, v61
  v_cvt_pk_bf16_f32 v111, v62, v63
  s_mov_b32 m0, s94
  v_mfma_f32_32x32x16_bf16 v[48:63], a[76:79], a[68:71], v[80:95]
  buffer_load_dwordx4 v21, s[16:19], s93 offen offset:0 sc1 lds
  v_exp_f32 v32, v32
  v_exp_f32 v33, v33
  v_exp_f32 v34, v34
  v_mfma_f32_32x32x16_bf16 a[224:239], a[88:91], v[108:111], a[224:239]
  ds_read_b128 a[80:83], v0 offset:4608
  ds_read_b128 a[88:91], v0 offset:5184
  ds_read_b128 a[72:75], v10 offset:4096
  v_exp_f32 v35, v35
  v_exp_f32 v36, v36
  v_exp_f32 v37, v37
  v_exp_f32 v38, v38
  v_exp_f32 v39, v39
  v_cvt_pk_bf16_f32 v96, v32, v33
  v_cvt_pk_bf16_f32 v97, v34, v35
  v_cvt_pk_bf16_f32 v98, v36, v37
  v_cvt_pk_bf16_f32 v99, v38, v39
  v_exp_f32 v40, v40
  v_exp_f32 v41, v41
  v_mfma_f32_32x32x16_bf16 a[208:223], a[84:87], v[96:99], a[208:223]
  v_exp_f32 v42, v42
  v_exp_f32 v43, v43
  v_exp_f32 v44, v44
  v_exp_f32 v45, v45
  v_exp_f32 v46, v46
  v_exp_f32 v47, v47
  v_cvt_pk_bf16_f32 v100, v40, v41
  v_cvt_pk_bf16_f32 v101, v42, v43
  v_cvt_pk_bf16_f32 v102, v44, v45
  v_cvt_pk_bf16_f32 v103, v46, v47
  s_waitcnt lgkmcnt(0)
  v_mfma_f32_32x32x16_bf16 v[32:47], a[72:75], a[64:67], v[64:79]
  buffer_load_dwordx4 v21, s[16:19], s93 offen offset:1024 sc1 lds
  v_add_u32 v10, 0x1000, v10
  v_add_u32 v0, 4608, v0
  v_exp_f32 v48, v48
  v_exp_f32 v49, v49
  v_exp_f32 v50, v50
  v_mfma_f32_32x32x16_bf16 a[208:223], a[92:95], v[100:103], a[208:223]
  v_exp_f32 v51, v51
  v_exp_f32 v52, v52
  v_exp_f32 v53, v53
  v_exp_f32 v54, v54
  v_exp_f32 v55, v55
  v_cvt_pk_bf16_f32 v104, v48, v49
  v_cvt_pk_bf16_f32 v105, v50, v51
  v_cvt_pk_bf16_f32 v106, v52, v53
  v_cvt_pk_bf16_f32 v107, v54, v55
  v_exp_f32 v56, v56
  v_exp_f32 v57, v57
  v_mfma_f32_32x32x16_bf16 a[224:239], a[84:87], v[104:107], a[224:239]
  buffer_load_dwordx4 v21, s[16:19], s93 offen offset:2048 sc1 lds
  s_add_u32 s93, s93, 3072
  s_add_u32 s94, s94, 3072
  v_exp_f32 v58, v58
  v_exp_f32 v59, v59
  v_exp_f32 v60, v60
  v_exp_f32 v61, v61
  v_exp_f32 v62, v62
  v_exp_f32 v63, v63
  v_cvt_pk_bf16_f32 v108, v56, v57
  v_cvt_pk_bf16_f32 v109, v58, v59
  v_cvt_pk_bf16_f32 v110, v60, v61
  v_cvt_pk_bf16_f32 v111, v62, v63
  s_cmp_lg_u32 s67, 0
  s_cbranch_scc1 L_att0_nosync
  s_waitcnt vmcnt(17)
  s_barrier
  s_lshl_b32 s72, s59, 8
  s_add_u32 s72, s72, 16781312
  s_cmp_lg_u32 s56, 0
  s_cbranch_scc1 L_sig_7
  v_mov_b32 v24, 1
  s_mov_b64 exec, 1
  buffer_atomic_add v24, v3, s[16:19], s72 offen sc1
  s_mov_b64 exec, -1
L_sig_7:
  s_mov_b32 s93, s100
  s_mov_b32 s94, s101
L_att0_nosync:
  s_add_u32 s67, s67, 1
  s_cmp_lt_u32 s67, 2
  s_cbranch_scc1 L_att0
  s_waitcnt vmcnt(5)
  v_readfirstlane_b32 s88, v2
  s_nop 0
  s_cmp_ge_u32 s88, 16
  s_cbranch_scc1 L_polled_9
  s_mov_b32 s89, 0
L_poll_8:
  s_sleep 2
  buffer_load_dword v2, v3, s[16:19], s58 offen sc1
  s_add_u32 s89, s89, 1
  s_waitcnt vmcnt(0)
  v_readfirstlane_b32 s88, v2
  s_cmp_gt_u32 s89, 200000
  s_cbranch_scc1 L_polled_9
  s_cmp_ge_u32 s88, 16
  s_cbranch_scc0 L_poll_8
L_polled_9:
  s_mov_b32 m0, s66
L_att1:
  s_waitcnt vmcnt(4)
  v_mfma_f32_32x32x16_bf16 v[48:63], a[72:75], a[68:71], v[80:95]
  ds_read_b64_tr_b16 a[96:97], v8 offset:0
  ds_read_b64_tr_b16 a[98:99], v8 offset:1024
  ds_read_b64_tr_b16 a[100:101], v9 offset:0
  ds_read_b64_tr_b16 a[102:103], v9 offset:1024
  v_exp_f32 v32, v32
  v_exp_f32 v33, v33
  v_exp_f32 v34, v34
  v_mfma_f32_32x32x16_bf16 a[224:239], a[92:95], v[108:111], a[224:239]
  ds_read_b64_tr_b16 a[104:105], v8 offset:2048
  ds_read_b64_tr_b16 a[106:107], v8 offset:3072
  ds_read_b64_tr_b16 a[108:109], v9 offset:2048
  ds_read_b64_tr_b16 a[110:111], v9 offset:3072
  ds_read_b128 a[84:87], v0 offset:1152
  ds_read_b128 a[92:95], v0 offset:1728
  ds_read_b128 a[76:79], v10 offset:1024
  v_exp_f32 v35, v35
  v_exp_f32 v36, v36
  v_exp_f32 v37, v37
  v_exp_f32 v38, v38
  v_exp_f32 v39, v39
  v_cvt_pk_bf16_f32 v96, v32, v33
  v_cvt_pk_bf16_f32 v97, v34, v35
  v_cvt_pk_bf16_f32 v98, v36, v37
  v_cvt_pk_bf16_f32 v99, v38, v39
  v_exp_f32 v40, v40
  v_exp_f32 v41, v41
  v_mfma_f32_32x32x16_bf16 a[208:223], a[80:83], v[96:99], a[208:223]
  v_exp_f32 v42, v42
  v_exp_f32 v43, v43
  v_exp_f32 v44, v44
  v_exp_f32 v45, v45
  v_exp_f32 v46, v46
  v_exp_f32 v47, v47
  v_cvt_pk_bf16_f32 v100, v40, v41
  v_cvt_pk_bf16_f32 v101, v42, v43
  v_cvt_pk_bf16_f32 v102, v44, v45
  v_cvt_pk_bf16_f32 v103, v46, v47
  s_waitcnt lgkmcnt(0)
  v_mfma_f32_32x32x16_bf16 v[32:47], a[76:79], a[64:67], v[64:79]
  v_exp_f32 v48, v48
  v_exp_f32 v49, v49
  v_exp_f32 v50, v50
  v_mfma_f32_32x32x16_bf16 a[208:223], a[88:91], v[100:103], a[208:223]
  v_exp_f32 v51, v51
  v_exp_f32 v52, v52
  v_exp_f32 v53, v53
  v_exp_f32 v54, v54
  s_waitcnt vmcnt(0)
  v_mfma_f32_32x32x16_bf16 a[144:159], a[96:99], a[240:243], a[144:159]
  v_exp_f32 v55, v55
  v_cvt_pk_bf16_f32 v104, v48, v49
  v_cvt_pk_bf16_f32 v105, v50, v51
  v_cvt_pk_bf16_f32 v106, v52, v53
  v_cvt_pk_bf16_f32 v107, v54, v55
  v_exp_f32 v56, v56
  v_exp_f32 v57, v57
  v_mfma_f32_32x32x16_bf16 a[224:239], a[80:83], v[104:107], a[224:239]
  v_exp_f32 v58, v58
  v_exp_f32 v59, v59
  v_exp_f32 v60, v60
  v_exp_f32 v61, v61
  v_mfma_f32_32x32x16_bf16 a[160:175], a[96:99], a[244:247], a[160:175]
  v_exp_f32 v62, v62
  v_exp_f32 v63, v63
  v_cvt_pk_bf16_f32 v108, v56, v57
  v_cvt_pk_bf16_f32 v109, v58, v59
  v_cvt_pk_bf16_f32 v110, v60, v61
  v_cvt_pk_bf16_f32 v111, v62, v63
  v_mfma_f32_32x32x16_bf16 v[48:63], a[76:79], a[68:71], v[80:95]
  buffer_load_dwordx4 v4, s[20:23], s65 offen offset:0 lds
  v_exp_f32 v32, v32
  v_exp_f32 v33, v33
  v_exp_f32 v34, v34
  v_mfma_f32_32x32x16_bf16 a[224:239], a[88:91], v[108:111], a[224:239]
  ds_read_b128 a[80:83], v0 offset:2304
  ds_read_b128 a[88:91], v0 offset:2880
  ds_read_b128 a[72:75], v10 offset:2048
  v_exp_f32 v35, v35
  v_exp_f32 v36, v36
  v_exp_f32 v37, v37
  v_exp_f32 v38, v38
  v_mfma_f32_32x32x16_bf16 a[176:191], a[100:103], a[240:243], a[176:191]
  buffer_load_dwordx4 v5, s[20:23], s65 offen offset:1024 lds
  v_exp_f32 v39, v39
  v_cvt_pk_bf16_f32 v96, v32, v33
  v_cvt_pk_bf16_f32 v97, v34, v35
  v_cvt_pk_bf16_f32 v98, v36, v37
  v_cvt_pk_bf16_f32 v99, v38, v39
  v_exp_f32 v40, v40
  v_exp_f32 v41, v41
  v_mfma_f32_32x32x16_bf16 a[208:223], a[84:87], v[96:99], a[208:223]
  buffer_load_dwordx4 v6, s[20:23], s65 offen offset:2048 lds
  v_exp_f32 v42, v42
  v_exp_f32 v43, v43
  v_exp_f32 v44, v44
  v_exp_f32 v45, v45
  v_mfma_f32_32x32x16_bf16 a[192:207], a[100:103], a[244:247], a[192:207]
  buffer_load_dwordx4 v7, s[20:23], s65 offen offset:3072 lds
  v_exp_f32 v46, v46
  v_exp_f32 v47, v47
  v_cvt_pk_bf16_f32 v100, v40, v41
  v_cvt_pk_bf16_f32 v101, v42, v43
  v_cvt_pk_bf16_f32 v102, v44, v45
  v_cvt_pk_bf16_f32 v103, v46, v47
  s_waitcnt lgkmcnt(0)
  v_mfma_f32_32x32x16_bf16 v[32:47], a[72:75], a[64:67], v[64:79]
  v_exp_f32 v48, v48
  v_exp_f32 v49, v49
  v_exp_f32 v50, v50
  v_mfma_f32_32x32x16_bf16 a[208:223], a[92:95], v[100:103], a[208:223]
  v_exp_f32 v51, v51
  v_exp_f32 v52, v52
  v_exp_f32 v53, v53
  v_exp_f32 v54, v54
  v_mfma_f32_32x32x16_bf16 a[144:159], a[104:107], a[248:251], a[144:159]
  v_exp_f32 v55, v55
  v_cvt_pk_bf16_f32 v104, v48, v49
  v_cvt_pk_bf16_f32 v105, v50, v51
  v_cvt_pk_bf16_f32 v106, v52, v53
  v_cvt_pk_bf16_f32 v107, v54, v55
  v_exp_f32 v56, v56
  v_exp_f32 v57, v57
  v_mfma_f32_32x32x16_bf16 a[224:239], a[84:87], v[104:107], a[224:239]
  v_exp_f32 v58, v58
  v_exp_f32 v59, v59
  v_exp_f32 v60, v60
  v_exp_f32 v61, v61
  v_mfma_f32_32x32x16_bf16 a[160:175], a[104:107], a[252:255], a[160:175]
  v_exp_f32 v62, v62
  v_exp_f32 v63, v63
  v_cvt_pk_bf16_f32 v108, v56, v57
  v_cvt_pk_bf16_f32 v109, v58, v59
  v_cvt_pk_bf16_f32 v110, v60, v61
  v_cvt_pk_bf16_f32 v111, v62, v63
  v_mfma_f32_32x32x16_bf16 v[48:63], a[72:75], a[68:71], v[80:95]
  v_exp_f32 v32, v32
  v_exp_f32 v33, v33
  v_exp_f32 v34, v34
  v_mfma_f32_32x32x16_bf16 a[224:239], a[92:95], v[108:111], a[224:239]
  ds_read_b128 a[84:87], v0 offset:3456
  ds_read_b128 a[92:95], v0 offset:4032
  ds_read_b128 a[76:79], v10 offset:3072
  v_exp_f32 v35, v35
  v_exp_f32 v36, v36
  v_exp_f32 v37, v37
  v_exp_f32 v38, v38
  v_mfma_f32_32x32x16_bf16 a[176:191], a[108:111], a[248:251], a[176:191]
  v_exp_f32 v39, v39
  v_cvt_pk_bf16_f32 v96, v32, v33
  v_cvt_pk_bf16_f32 v97, v34, v35
  v_cvt_pk_bf16_f32 v98, v36, v37
  v_cvt_pk_bf16_f32 v99, v38, v39
  v_exp_f32 v40, v40
  v_exp_f32 v41, v41
  v_mfma_f32_32x32x16_bf16 a[208:223], a[80:83], v[96:99], a[208:223]
  v_exp_f32 v42, v42
  v_exp_f32 v43, v43
  v_exp_f32 v44, v44
  v_exp_f32 v45, v45
  v_mfma_f32_32x32x16_bf16 a[192:207], a[108:111], a[252:255], a[192:207]
  v_exp_f32 v46, v46
  v_exp_f32 v47, v47
  v_cvt_pk_bf16_f32 v100, v40, v41
  v_cvt_pk_bf16_f32 v101, v42, v43
  v_cvt_pk_bf16_f32 v102, v44, v45
  v_cvt_pk_bf16_f32 v103, v46, v47
  s_waitcnt lgkmcnt(0)
  v_mfma_f32_32x32x16_bf16 v[32:47], a[76:79], a[64:67], v[64:79]
  buffer_load_dwordx4 a[240:243], v21, s[16:19], s63 offen offset:0 sc1
  buffer_load_dwordx4 a[244:247], v14, s[16:19], s63 offen offset:0 sc1
  v_exp_f32 v48, v48
  v_exp_f32 v49, v49
  v_exp_f32 v50, v50
  v_mfma_f32_32x32x16_bf16 a[208:223], a[88:91], v[100:103], a[208:223]
  buffer_load_dwordx4 a[248:251], v21, s[16:19], s63 offen offset:1024 sc1
  buffer_load_dwordx4 a[252:255], v14, s[16:19], s63 offen offset:1024 sc1
  v_exp_f32 v51, v51
  v_exp_f32 v52, v52
  v_exp_f32 v53, v53
  v_exp_f32 v54, v54
  v_exp_f32 v55, v55
  v_cvt_pk_bf16_f32 v104, v48, v49
  v_cvt_pk_bf16_f32 v105, v50, v51
  v_cvt_pk_bf16_f32 v106, v52, v53
  v_cvt_pk_bf16_f32 v107, v54, v55
  v_exp_f32 v56, v56
  v_exp_f32 v57, v57
  v_mfma_f32_32x32x16_bf16 a[224:239], a[80:83], v[104:107], a[224:239]
  s_add_u32 s63, s63, 2048
  s_add_u32 s65, s65, 0x8000
  v_exp_f32 v58, v58
  v_exp_f32 v59, v59
  v_exp_f32 v60, v60
  v_exp_f32 v61, v61
  v_exp_f32 v62, v62
  v_exp_f32 v63, v63
  v_cvt_pk_bf16_f32 v108, v56, v57
  v_cvt_pk_bf16_f32 v109, v58, v59
  v_cvt_pk_bf16_f32 v110, v60, v61
  v_cvt_pk_bf16_f32 v111, v62, v63
  v_mfma_f32_32x32x16_bf16 v[48:63], a[76:79], a[68:71], v[80:95]
  v_exp_f32 v32, v32
  v_exp_f32 v33, v33
  v_exp_f32 v34, v34
  v_mfma_f32_32x32x16_bf16 a[224:239], a[88:91], v[108:111], a[224:239]
  ds_read_b128 a[80:83], v0 offset:4608
  ds_read_b128 a[88:91], v0 offset:5184
  ds_read_b128 a[72:75], v10 offset:4096
  v_exp_f32 v35, v35
  v_exp_f32 v36, v36
  v_exp_f32 v37, v37
  v_exp_f32 v38, v38
  v_exp_f32 v39, v39
  v_cvt_pk_bf16_f32 v96, v32, v33
  v_cvt_pk_bf16_f32 v97, v34, v35
  v_cvt_pk_bf16_f32 v98, v36, v37
  v_cvt_pk_bf16_f32 v99, v38, v39
  v_exp_f32 v40, v40
  v_exp_f32 v41, v41
  v_mfma_f32_32x32x16_bf16 a[208:223], a[84:87], v[96:99], a[208:223]
  v_exp_f32 v42, v42
  v_exp_f32 v43, v43
  v_exp_f32 v44, v44
  v_exp_f32 v45, v45
  v_exp_f32 v46, v46
  v_exp_f32 v47, v47
  v_cvt_pk_bf16_f32 v100, v40, v41
  v_cvt_pk_bf16_f32 v101, v42, v43
  v_cvt_pk_bf16_f32 v102, v44, v45
  v_cvt_pk_bf16_f32 v103, v46, v47
  s_waitcnt lgkmcnt(0)
  v_mfma_f32_32x32x16_bf16 v[32:47], a[72:75], a[64:67], v[64:79]
  v_add_u32 v10, 0x1000, v10
  v_add_u32 v0, 4608, v0
  v_exp_f32 v48, v48
  v_exp_f32 v49, v49
  v_exp_f32 v50, v50
  v_mfma_f32_32x32x16_bf16 a[208:223], a[92:95], v[100:103], a[208:223]
  v_exp_f32 v51, v51
  v_exp_f32 v52, v52
  v_exp_f32 v53, v53
  v_exp_f32 v54, v54
  v_exp_f32 v55, v55
  v_cvt_pk_bf16_f32 v104, v48, v49
  v_cvt_pk_bf16_f32 v105, v50, v51
  v_cvt_pk_bf16_f32 v106, v52, v53
  v_cvt_pk_bf16_f32 v107, v54, v55
  v_exp_f32 v56, v56
  v_exp_f32 v57, v57
  v_mfma_f32_32x32x16_bf16 a[224:239], a[84:87], v[104:107], a[224:239]
  v_exp_f32 v58, v58
  v_exp_f32 v59, v59
  v_exp_f32 v60, v60
  v_exp_f32 v61, v61
  v_exp_f32 v62, v62
  v_exp_f32 v63, v63
  v_cvt_pk_bf16_f32 v108, v56, v57
  v_cvt_pk_bf16_f32 v109, v58, v59
  v_cvt_pk_bf16_f32 v110, v60, v61
  v_cvt_pk_bf16_f32 v111, v62, v63
  s_cmp_lg_u32 s67, 2
  s_cbranch_scc1 L_att1_nopub
  s_waitcnt vmcnt(8)
  s_barrier
L_att1_nopub:
  s_add_u32 s67, s67, 1
  s_cmp_lt_u32 s67, 16
  s_cbranch_scc1 L_att1
  v_mfma_f32_32x32x16_bf16 a[224:239], a[92:95], v[108:111], a[224:239]
  s_mov_b32 s87, 0
L_fin:
  v_accvgpr_read_b32 v32, a208
  v_accvgpr_read_b32 v33, a209
  v_accvgpr_read_b32 v34, a210
  v_accvgpr_read_b32 v35, a211
  v_accvgpr_read_b32 v36, a212
  v_accvgpr_read_b32 v37, a213
  v_accvgpr_read_b32 v38, a214
  v_accvgpr_read_b32 v39, a215
  v_accvgpr_read_b32 v40, a216
  s_nop 1
  v_accvgpr_read_b32 v48, a224
  v_accvgpr_read_b32 v49, a225
  v_accvgpr_read_b32 v50, a226
  v_accvgpr_read_b32 v51, a227
  v_accvgpr_read_b32 v52, a228
  v_accvgpr_read_b32 v53, a229
  v_accvgpr_read_b32 v54, a230
  v_accvgpr_read_b32 v55, a231
  v_accvgpr_read_b32 v56, a232
  v_mov_b32 v41, v40
  v_mov_b32 v57, v56
  s_nop 0
  v_permlane32_swap_b32 v40, v41
  v_permlane32_swap_b32 v56, v57
  v_max3_f32 v24, |v32|, |v33|, |v34|
  v_max3_f32 v24, v24, |v35|, |v36|
  v_max3_f32 v24, v24, |v37|, |v38|
  v_max3_f32 v24, v24, |v39|, |v40|
  v_max3_f32 v24, v24, |v48|, |v49|
  v_max3_f32 v24, v24, |v50|, |v51|
  v_max3_f32 v24, v24, |v52|, |v53|
  v_max3_f32 v24, v24, |v54|, |v55|
  v_max_f32 v24, v24, v56
  v_add_f32 v25, v40, v56
  s_mov_b32 s88, 0x7e000000
  v_cmp_ngt_f32 vcc, s88, v24
  v_cmp_ngt_f32 s[84:85], s88, v25
  s_nop 4
  s_or_b64 vcc, vcc, s[84:85]
  s_cmp_lg_u32 s87, 0
  s_cbranch_scc1 L_fin_ok
  s_cmp_eq_u64 vcc, 0
  s_cbranch_scc1 L_fin_ok
  s_waitcnt vmcnt(0) lgkmcnt(0)
  v_add_u32 v26, 0, v21
  v_mov_b32 v24, 0xff800000
  v_mov_b32 v25, 0xff800000
  s_mov_b32 s88, 0
L_fb_max:
  ds_read_b128 a[72:75], v26
  v_add_u32 v26, 0x400, v26
  s_waitcnt lgkmcnt(0)
  v_mfma_f32_32x32x16_bf16 v[32:47], a[72:75], a[64:67], 0
  v_mfma_f32_32x32x16_bf16 v[48:63], a[72:75], a[68:71], 0
  s_nop 15
  s_nop 7
  v_max3_f32 v24, v24, v32, v33
  v_max3_f32 v24, v24, v34, v35
  v_max3_f32 v24, v24, v36, v37
  v_max3_f32 v24, v24, v38, v39
  v_max3_f32 v24, v24, v40, v41
  v_max3_f32 v24, v24, v42, v43
  v_max3_f32 v24, v24, v44, v45
  v_max3_f32 v24, v24, v46, v47
  v_max3_f32 v25, v25, v48, v49
  v_max3_f32 v25, v25, v50, v51
  v_max3_f32 v25, v25, v52, v53
  v_max3_f32 v25, v25, v54, v55
  v_max3_f32 v25, v25, v56, v57
  v_max3_f32 v25, v25, v58, v59
  v_max3_f32 v25, v25, v60, v61
  v_max3_f32 v25, v25, v62, v63
  s_add_u32 s88, s88, 1
  s_cmp_lt_u32 s88, 64
  s_cbranch_scc1 L_fb_max
  v_mov_b32 v27, v24
  s_nop 1
  v_permlane32_swap_b32 v24, v27
  s_nop 1
  v_max_f32 v24, v24, v27
  v_sub_f32 v64, 0, v24
  v_sub_f32 v65, 0, v24
  v_sub_f32 v66, 0, v24
  v_sub_f32 v67, 0, v24
  v_sub_f32 v68, 0, v24
  v_sub_f32 v69, 0, v24
  v_sub_f32 v70, 0, v24
  v_sub_f32 v71, 0, v24
  v_sub_f32 v72, 0, v24
  v_sub_f32 v73, 0, v24
  v_sub_f32 v74, 0, v24
  v_sub_f32 v75, 0, v24
  v_sub_f32 v76, 0, v24
  v_sub_f32 v77, 0, v24
  v_sub_f32 v78, 0, v24
  v_sub_f32 v79, 0, v24
  v_mov_b32 v27, v25
  s_nop 1
  v_permlane32_swap_b32 v25, v27
  s_nop 1
  v_max_f32 v25, v25, v27
  v_sub_f32 v80, 0, v25
  v_sub_f32 v81, 0, v25
  v_sub_f32 v82, 0, v25
  v_sub_f32 v83, 0, v25
  v_sub_f32 v84, 0, v25
  v_sub_f32 v85, 0, v25
  v_sub_f32 v86, 0, v25
  v_sub_f32 v87, 0, v25
  v_sub_f32 v88, 0, v25
  v_sub_f32 v89, 0, v25
  v_sub_f32 v90, 0, v25
  v_sub_f32 v91, 0, v25
  v_sub_f32 v92, 0, v25
  v_sub_f32 v93, 0, v25
  v_sub_f32 v94, 0, v25
  v_sub_f32 v95, 0, v25
  v_accvgpr_write_b32 a208, 0
  v_accvgpr_write_b32 a209, 0
  v_accvgpr_write_b32 a210, 0
  v_accvgpr_write_b32 a211, 0
  v_accvgpr_write_b32 a212, 0
  v_accvgpr_write_b32 a213, 0
  v_accvgpr_write_b32 a214, 0
  v_accvgpr_write_b32 a215, 0
  v_accvgpr_write_b32 a216, 0
  v_accvgpr_write_b32 a217, 0
  v_accvgpr_write_b32 a218, 0
  v_accvgpr_write_b32 a219, 0
  v_accvgpr_write_b32 a220, 0
  v_accvgpr_write_b32 a221, 0
  v_accvgpr_write_b32 a222, 0
  v_accvgpr_write_b32 a223, 0
  v_accvgpr_write_b32 a224, 0
  v_accvgpr_write_b32 a225, 0
  v_accvgpr_write_b32 a226, 0
  v_accvgpr_write_b32 a227, 0
  v_accvgpr_write_b32 a228, 0
  v_accvgpr_write_b32 a229, 0
  v_accvgpr_write_b32 a230, 0
  v_accvgpr_write_b32 a231, 0
  v_accvgpr_write_b32 a232, 0
  v_accvgpr_write_b32 a233, 0
  v_accvgpr_write_b32 a234, 0
  v_accvgpr_write_b32 a235, 0
  v_accvgpr_write_b32 a236, 0
  v_accvgpr_write_b32 a237, 0
  v_accvgpr_write_b32 a238, 0
  v_accvgpr_write_b32 a239, 0
  v_add_u32 v26, 0, v21
  v_subrev_u32 v27, 73728, v0
  s_mov_b32 s88, 0
L_fb_run:
  ds_read_b128 a[72:75], v26
  ds_read_b128 a[80:83], v27
  ds_read_b128 a[88:91], v27 offset:576
  v_add_u32 v26, 0x400, v26
  v_add_u32 v27, 1152, v27
  s_waitcnt lgkmcnt(0)
  v_mfma_f32_32x32x16_bf16 v[32:47], a[72:75], a[64:67], v[64:79]
  v_mfma_f32_32x32x16_bf16 v[48:63], a[72:75], a[68:71], v[80:95]
  s_nop 15
  s_nop 7
  v_exp_f32 v32, v32
  v_exp_f32 v33, v33
  v_exp_f32 v34, v34
  v_exp_f32 v35, v35
  v_exp_f32 v36, v36
  v_exp_f32 v37, v37
  v_exp_f32 v38, v38
  v_exp_f32 v39, v39
  v_exp_f32 v40, v40
  v_exp_f32 v41, v41
  v_exp_f32 v42, v42
  v_exp_f32 v43, v43
  v_exp_f32 v44, v44
  v_exp_f32 v45, v45
  v_exp_f32 v46, v46
  v_exp_f32 v47, v47
  s_nop 1
  v_cvt_pk_bf16_f32 v96, v32, v33
  v_cvt_pk_bf16_f32 v97, v34, v35
  v_cvt_pk_bf16_f32 v98, v36, v37
  v_cvt_pk_bf16_f32 v99, v38, v39
  v_cvt_pk_bf16_f32 v100, v40, v41
  v_cvt_pk_bf16_f32 v101, v42, v43
  v_cvt_pk_bf16_f32 v102, v44, v45
  v_cvt_pk_bf16_f32 v103, v46, v47
  v_exp_f32 v48, v48
  v_exp_f32 v49, v49
  v_exp_f32 v50, v50
  v_exp_f32 v51, v51
  v_exp_f32 v52, v52
  v_exp_f32 v53, v53
  v_exp_f32 v54, v54
  v_exp_f32 v55, v55
  v_exp_f32 v56, v56
  v_exp_f32 v57, v57
  v_exp_f32 v58, v58
  v_exp_f32 v59, v59
  v_exp_f32 v60, v60
  v_exp_f32 v61, v61
  v_exp_f32 v62, v62
  v_exp_f32 v63, v63
  s_nop 1
  v_cvt_pk_bf16_f32 v104, v48, v49
  v_cvt_pk_bf16_f32 v105, v50, v51
  v_cvt_pk_bf16_f32 v106, v52, v53
  v_cvt_pk_bf16_f32 v107, v54, v55
  v_cvt_pk_bf16_f32 v108, v56, v57
  v_cvt_pk_bf16_f32 v109, v58, v59
  v_cvt_pk_bf16_f32 v110, v60, v61
  v_cvt_pk_bf16_f32 v111, v62, v63
  s_nop 3
  v_mfma_f32_32x32x16_bf16 a[208:223], a[80:83], v[96:99], a[208:223]
  v_mfma_f32_32x32x16_bf16 a[208:223], a[88:91], v[100:103], a[208:223]
  v_mfma_f32_32x32x16_bf16 a[224:239], a[80:83], v[104:107], a[224:239]
  v_mfma_f32_32x32x16_bf16 a[224:239], a[88:91], v[108:111], a[224:239]
  s_add_u32 s88, s88, 1
  s_cmp_lt_u32 s88, 64
  s_cbranch_scc1 L_fb_run
  s_nop 15
  s_nop 7
  s_mov_b32 s87, 1
  s_branch L_fin
L_fin_ok:
  s_lshl_b32 s72, s81, 3
  s_lshl_b32 s73, s56, 1
  s_add_u32 s72, s72, s73
  s_lshl_b32 s72, s72, 15
  s_lshl_b32 s73, s80, 10
  s_add_u32 s72, s72, s73
  s_add_u32 s72, s72, 14680064
  v_rcp_f32 v24, v40
  s_nop 0
  v_mul_f32 v32, v32, v24
  v_mul_f32 v33, v33, v24
  v_mul_f32 v34, v34, v24
  v_mul_f32 v35, v35, v24
  v_mul_f32 v36, v36, v24
  v_mul_f32 v37, v37, v24
  v_mul_f32 v38, v38, v24
  v_mul_f32 v39, v39, v24
  v_cvt_pk_bf16_f32 v96, v32, v33
  v_cvt_pk_bf16_f32 v97, v34, v35
  v_cvt_pk_bf16_f32 v98, v36, v37
  v_cvt_pk_bf16_f32 v99, v38, v39
  buffer_store_dwordx4 v[96:99], v21, s[16:19], s72 offen sc0 sc1
  v_rcp_f32 v24, v56
  s_add_u32 s72, s72, 0x8000
  v_mul_f32 v48, v48, v24
  v_mul_f32 v49, v49, v24
  v_mul_f32 v50, v50, v24
  v_mul_f32 v51, v51, v24
  v_mul_f32 v52, v52, v24
  v_mul_f32 v53, v53, v24
  v_mul_f32 v54, v54, v24
  v_mul_f32 v55, v55, v24
  v_cvt_pk_bf16_f32 v104, v48, v49
  v_cvt_pk_bf16_f32 v105, v50, v51
  v_cvt_pk_bf16_f32 v106, v52, v53
  v_cvt_pk_bf16_f32 v107, v54, v55
  buffer_store_dwordx4 v[104:107], v21, s[16:19], s72 offen sc0 sc1
  s_waitcnt vmcnt(2)
  ds_read_b64_tr_b16 a[96:97], v8 offset:0
  ds_read_b64_tr_b16 a[98:99], v8 offset:1024
  ds_read_b64_tr_b16 a[100:101], v9 offset:0
  ds_read_b64_tr_b16 a[102:103], v9 offset:1024
  ds_read_b64_tr_b16 a[104:105], v8 offset:2048
  ds_read_b64_tr_b16 a[106:107], v8 offset:3072
  ds_read_b64_tr_b16 a[108:109], v9 offset:2048
  ds_read_b64_tr_b16 a[110:111], v9 offset:3072
  s_waitcnt lgkmcnt(6)
  v_mfma_f32_32x32x16_bf16 a[144:159], a[96:99], a[240:243], a[144:159]
  v_mfma_f32_32x32x16_bf16 a[160:175], a[96:99], a[244:247], a[160:175]
  s_waitcnt lgkmcnt(4)
  v_mfma_f32_32x32x16_bf16 a[176:191], a[100:103], a[240:243], a[176:191]
  v_mfma_f32_32x32x16_bf16 a[192:207], a[100:103], a[244:247], a[192:207]
  s_waitcnt lgkmcnt(2)
  v_mfma_f32_32x32x16_bf16 a[144:159], a[104:107], a[248:251], a[144:159]
  v_mfma_f32_32x32x16_bf16 a[160:175], a[104:107], a[252:255], a[160:175]
  s_waitcnt lgkmcnt(0)
  v_mfma_f32_32x32x16_bf16 a[176:191], a[108:111], a[248:251], a[176:191]
  v_mfma_f32_32x32x16_bf16 a[192:207], a[108:111], a[252:255], a[192:207]
  s_lshr_b32 s87, s82, 2
  s_lshl_b32 s87, s87, 8
  s_add_u32 s87, s87, 16785408
  s_lshl_b32 s84, s56, 17
  s_lshl_b32 s74, s83, 7
  s_add_u32 s84, s84, s74
  s_lshl_b32 s85, s56, 14
  s_lshl_b32 s72, s56, 12
  s_add_u32 s72, s72, 0x10000
  v_add_u32 v24, s72, v21
  s_add_u32 s72, s85, 0x10000
  v_add_u32 v25, s72, v21
  s_lshr_b32 s72, s56, 1
  s_lshl_b32 s72, s72, 6
  v_subrev_u32 v13, s66, v8
  v_xor_b32 v13, s72, v13
  s_and_b32 s72, s56, 1
  s_lshl_b32 s72, s72, 15
  s_add_u32 s72, s72, 0x10000
  v_add_u32 v15, s72, v21
  s_waitcnt vmcnt(0)
  s_barrier
  s_lshl_b32 s72, s81, 8
  s_add_u32 s72, s72, 16785408
  s_cmp_lg_u32 s56, 0
  s_cbranch_scc1 L_sig_10
  v_mov_b32 v26, 1
  s_mov_b64 exec, 1
  buffer_atomic_add v26, v3, s[16:19], s72 offen sc1
  s_mov_b64 exec, -1
L_sig_10:
  ds_write_b128 v24, a[144:147] offset:0
  ds_write_b128 v24, a[148:151] offset:1024
  ds_write_b128 v24, a[152:155] offset:2048
  ds_write_b128 v24, a[156:159] offset:3072
  ds_write_b128 v24, a[160:163] offset:16384
  ds_write_b128 v24, a[164:167] offset:17408
  ds_write_b128 v24, a[168:171] offset:18432
  ds_write_b128 v24, a[172:175] offset:19456
  ds_write_b128 v24, a[176:179] offset:32768
  ds_write_b128 v24, a[180:183] offset:33792
  ds_write_b128 v24, a[184:187] offset:34816
  ds_write_b128 v24, a[188:191] offset:35840
  ds_write_b128 v24, a[192:195] offset:49152
  ds_write_b128 v24, a[196:199] offset:50176
  ds_write_b128 v24, a[200:203] offset:51200
  ds_write_b128 v24, a[204:207] offset:52224
  s_waitcnt lgkmcnt(0)
  s_barrier
  ds_read_b128 v[192:195], v25 offset:0
  ds_read_b128 v[196:199], v25 offset:1024
  ds_read_b128 v[200:203], v25 offset:2048
  ds_read_b128 v[204:207], v25 offset:3072
  ds_read_b128 v[208:211], v25 offset:4096
  ds_read_b128 v[212:215], v25 offset:5120
  ds_read_b128 v[216:219], v25 offset:6144
  ds_read_b128 v[220:223], v25 offset:7168
  ds_read_b128 v[224:227], v25 offset:8192
  ds_read_b128 v[228:231], v25 offset:9216
  ds_read_b128 v[232:235], v25 offset:10240
  ds_read_b128 v[236:239], v25 offset:11264
  ds_read_b128 v[240:243], v25 offset:12288
  ds_read_b128 v[244:247], v25 offset:13312
  ds_read_b128 v[248:251], v25 offset:14336
  ds_read_b128 v[252:255], v25 offset:15360
  s_add_u32 s75, s84, 0
  s_add_u32 m0, s85, 0
  v_lshlrev_b32 v128, 16, v112
  buffer_load_dwordx4 v4, s[24:27], s75 offen lds
  v_and_b32 v129, v20, v112
  v_lshlrev_b32 v130, 16, v113
  v_and_b32 v131, v20, v113
  v_lshlrev_b32 v132, 16, v114
  s_add_u32 s75, s84, 8192
  s_add_u32 m0, s85, 1024
  v_and_b32 v133, v20, v114
  buffer_load_dwordx4 v4, s[24:27], s75 offen lds
  v_lshlrev_b32 v134, 16, v115
  v_and_b32 v135, v20, v115
  v_lshlrev_b32 v136, 16, v116
  v_and_b32 v137, v20, v116
  s_add_u32 s75, s84, 16384
  s_add_u32 m0, s85, 2048
  v_lshlrev_b32 v138, 16, v117
  buffer_load_dwordx4 v4, s[24:27], s75 offen lds
  v_and_b32 v139, v20, v117
  v_lshlrev_b32 v140, 16, v118
  v_and_b32 v141, v20, v118
  v_lshlrev_b32 v142, 16, v119
  s_add_u32 s75, s84, 24576
  s_add_u32 m0, s85, 3072
  v_and_b32 v143, v20, v119
  buffer_load_dwordx4 v4, s[24:27], s75 offen lds
  s_waitcnt lgkmcnt(11)
  v_add_f32 v192, v192, v208
  v_add_f32 v193, v193, v209
  v_add_f32 v194, v194, v210
  v_add_f32 v195, v195, v211
  s_add_u32 s75, s84, 32768
  s_add_u32 m0, s85, 4096
  s_waitcnt lgkmcnt(10)
  v_add_f32 v196, v196, v212
  buffer_load_dwordx4 v4, s[24:27], s75 offen lds
  v_add_f32 v197, v197, v213
  v_add_f32 v198, v198, v214
  v_add_f32 v199, v199, v215
  s_waitcnt lgkmcnt(9)
  v_add_f32 v200, v200, v216
  s_add_u32 s75, s84, 40960
  s_add_u32 m0, s85, 5120
  v_add_f32 v201, v201, v217
  buffer_load_dwordx4 v4, s[24:27], s75 offen lds
  v_add_f32 v202, v202, v218
  v_add_f32 v203, v203, v219
  s_waitcnt lgkmcnt(8)
  v_add_f32 v204, v204, v220
  v_add_f32 v205, v205, v221
  s_add_u32 s75, s84, 49152
  s_add_u32 m0, s85, 6144
  v_add_f32 v206, v206, v222
  buffer_load_dwordx4 v4, s[24:27], s75 offen lds
  v_add_f32 v207, v207, v223
  s_waitcnt lgkmcnt(3)
  v_add_f32 v224, v224, v240
  v_add_f32 v225, v225, v241
  v_add_f32 v226, v226, v242
  s_add_u32 s75, s84, 57344
  s_add_u32 m0, s85, 7168
  v_add_f32 v227, v227, v243
  buffer_load_dwordx4 v4, s[24:27], s75 offen lds
  s_waitcnt lgkmcnt(2)
  v_add_f32 v228, v228, v244
  v_add_f32 v229, v229, v245
  v_add_f32 v230, v230, v246
  v_add_f32 v231, v231, v247
  s_add_u32 s75, s84, 65536
  s_add_u32 m0, s85, 8192
  s_waitcnt lgkmcnt(1)
  v_add_f32 v232, v232, v248
  buffer_load_dwordx4 v4, s[24:27], s75 offen lds
  v_add_f32 v233, v233, v249
  v_add_f32 v234, v234, v250
  v_add_f32 v235, v235, v251
  s_waitcnt lgkmcnt(0)
  v_add_f32 v236, v236, v252
  s_add_u32 s75, s84, 73728
  s_add_u32 m0, s85, 9216
  v_add_f32 v237, v237, v253
  buffer_load_dwordx4 v4, s[24:27], s75 offen lds
  v_add_f32 v238, v238, v254
  v_add_f32 v239, v239, v255
  v_add_f32 v192, v192, v128
  v_add_f32 v193, v193, v129
  s_add_u32 s75, s84, 81920
  s_add_u32 m0, s85, 10240
  v_add_f32 v194, v194, v130
  buffer_load_dwordx4 v4, s[24:27], s75 offen lds
  v_add_f32 v195, v195, v131
  v_add_f32 v196, v196, v132
  v_add_f32 v197, v197, v133
  v_add_f32 v198, v198, v134
  s_add_u32 s75, s84, 90112
  s_add_u32 m0, s85, 11264
  v_add_f32 v199, v199, v135
  buffer_load_dwordx4 v4, s[24:27], s75 offen lds
  v_add_f32 v200, v200, v136
  v_add_f32 v201, v201, v137
  v_add_f32 v202, v202, v138
  v_add_f32 v203, v203, v139
  s_add_u32 s75, s84, 98304
  s_add_u32 m0, s85, 12288
  v_add_f32 v204, v204, v140
  buffer_load_dwordx4 v4, s[24:27], s75 offen lds
  v_add_f32 v205, v205, v141
  v_add_f32 v206, v206, v142
  v_add_f32 v207, v207, v143
  v_add_f32 v192, v192, v224
  s_add_u32 s75, s84, 106496
  s_add_u32 m0, s85, 13312
  v_add_f32 v193, v193, v225
  buffer_load_dwordx4 v4, s[24:27], s75 offen lds
  v_add_f32 v194, v194, v226
  v_add_f32 v195, v195, v227
  v_add_f32 v196, v196, v228
  v_add_f32 v197, v197, v229
  s_add_u32 s75, s84, 114688
  s_add_u32 m0, s85, 14336
  v_add_f32 v198, v198, v230
  buffer_load_dwordx4 v4, s[24:27], s75 offen lds
  v_add_f32 v199, v199, v231
  v_add_f32 v200, v200, v232
  v_add_f32 v201, v201, v233
  v_add_f32 v202, v202, v234
  s_add_u32 s75, s84, 122880
  s_add_u32 m0, s85, 15360
  v_add_f32 v203, v203, v235
  buffer_load_dwordx4 v4, s[24:27], s75 offen lds
  v_add_f32 v204, v204, v236
  v_add_f32 v205, v205, v237
  v_add_f32 v206, v206, v238
  v_add_f32 v207, v207, v239
  s_lshl_b32 s84, s82, 16
  s_add_u32 s84, s84, 14680064
  s_lshr_b32 s72, s56, 1
  s_lshl_b32 s72, s72, 15
  s_and_b32 s73, s56, 1
  s_lshl_b32 s73, s73, 12
  s_add_u32 s85, s72, s73
  s_add_u32 s84, s84, s85
  s_add_u32 s85, s85, 0x10000
  s_cmp_lg_u32 s56, 0
  s_cbranch_scc1 L_w0p_11
  s_mov_b32 s88, 0
  s_cmp_ge_u32 s88, 32
  s_cbranch_scc1 L_polled_13
  s_mov_b32 s89, 0
L_poll_12:
  s_sleep 2
  buffer_load_dword v2, v3, s[16:19], s87 offen sc1
  s_add_u32 s89, s89, 1
  s_waitcnt vmcnt(0)
  v_readfirstlane_b32 s88, v2
  s_cmp_gt_u32 s89, 200000
  s_cbranch_scc1 L_polled_13
  s_cmp_ge_u32 s88, 32
  s_cbranch_scc0 L_poll_12
L_polled_13:
L_w0p_11:
  s_waitcnt vmcnt(0)
  s_barrier
  s_add_u32 s75, s84, 0
  s_add_u32 m0, s85, 0
  s_nop 0
  buffer_load_dwordx4 v21, s[16:19], s75 offen offset:0 sc1 lds
  buffer_load_dwordx4 v21, s[16:19], s75 offen offset:1024 sc1 lds
  buffer_load_dwordx4 v21, s[16:19], s75 offen offset:2048 sc1 lds
  buffer_load_dwordx4 v21, s[16:19], s75 offen offset:3072 sc1 lds
  s_add_u32 s75, s84, 8192
  s_add_u32 m0, s85, 8192
  s_nop 0
  buffer_load_dwordx4 v21, s[16:19], s75 offen offset:0 sc1 lds
  buffer_load_dwordx4 v21, s[16:19], s75 offen offset:1024 sc1 lds
  buffer_load_dwordx4 v21, s[16:19], s75 offen offset:2048 sc1 lds
  buffer_load_dwordx4 v21, s[16:19], s75 offen offset:3072 sc1 lds
  s_add_u32 s75, s84, 16384
  s_add_u32 m0, s85, 16384
  s_nop 0
  buffer_load_dwordx4 v21, s[16:19], s75 offen offset:0 sc1 lds
  buffer_load_dwordx4 v21, s[16:19], s75 offen offset:1024 sc1 lds
  buffer_load_dwordx4 v21, s[16:19], s75 offen offset:2048 sc1 lds
  buffer_load_dwordx4 v21, s[16:19], s75 offen offset:3072 sc1 lds
  s_add_u32 s75, s84, 24576
  s_add_u32 m0, s85, 24576
  s_nop 0
  buffer_load_dwordx4 v21, s[16:19], s75 offen offset:0 sc1 lds
  buffer_load_dwordx4 v21, s[16:19], s75 offen offset:1024 sc1 lds
  buffer_load_dwordx4 v21, s[16:19], s75 offen offset:2048 sc1 lds
  buffer_load_dwordx4 v21, s[16:19], s75 offen offset:3072 sc1 lds
  ds_read_b64_tr_b16 a[32:33], v13 offset:0
  ds_read_b64_tr_b16 a[34:35], v13 offset:1024
  ds_read_b64_tr_b16 a[36:37], v13 offset:2048
  ds_read_b64_tr_b16 a[38:39], v13 offset:3072
  ds_read_b64_tr_b16 a[40:41], v13 offset:4096
  ds_read_b64_tr_b16 a[42:43], v13 offset:5120
  ds_read_b64_tr_b16 a[44:45], v13 offset:6144
  ds_read_b64_tr_b16 a[46:47], v13 offset:7168
  ds_read_b64_tr_b16 a[48:49], v13 offset:8192
  ds_read_b64_tr_b16 a[50:51], v13 offset:9216
  ds_read_b64_tr_b16 a[52:53], v13 offset:10240
  ds_read_b64_tr_b16 a[54:55], v13 offset:11264
  ds_read_b64_tr_b16 a[56:57], v13 offset:12288
  ds_read_b64_tr_b16 a[58:59], v13 offset:13312
  ds_read_b64_tr_b16 a[60:61], v13 offset:14336
  ds_read_b64_tr_b16 a[62:63], v13 offset:15360
  s_waitcnt vmcnt(12)
  s_barrier
  ds_read_b128 a[0:3], v15 offset:0
  ds_read_b128 a[4:7], v15 offset:1024
  ds_read_b128 a[8:11], v15 offset:2048
  ds_read_b128 a[12:15], v15 offset:3072
  ds_read_b128 a[16:19], v15 offset:4096
  ds_read_b128 a[20:23], v15 offset:5120
  ds_read_b128 a[24:27], v15 offset:6144
  ds_read_b128 a[28:31], v15 offset:7168
  s_waitcnt lgkmcnt(7)
  v_mfma_f32_32x32x16_bf16 v[192:207], a[32:35], a[0:3], v[192:207]
  s_waitcnt lgkmcnt(6)
  v_mfma_f32_32x32x16_bf16 v[192:207], a[36:39], a[4:7], v[192:207]
  s_waitcnt lgkmcnt(5)
  v_mfma_f32_32x32x16_bf16 v[192:207], a[40:43], a[8:11], v[192:207]
  s_waitcnt lgkmcnt(4)
  v_mfma_f32_32x32x16_bf16 v[192:207], a[44:47], a[12:15], v[192:207]
  s_waitcnt lgkmcnt(3)
  v_mfma_f32_32x32x16_bf16 v[192:207], a[48:51], a[16:19], v[192:207]
  s_waitcnt lgkmcnt(2)
  v_mfma_f32_32x32x16_bf16 v[192:207], a[52:55], a[20:23], v[192:207]
  s_waitcnt lgkmcnt(1)
  v_mfma_f32_32x32x16_bf16 v[192:207], a[56:59], a[24:27], v[192:207]
  s_waitcnt lgkmcnt(0)
  v_mfma_f32_32x32x16_bf16 v[192:207], a[60:63], a[28:31], v[192:207]
  ds_read_b64_tr_b16 a[32:33], v13 offset:16384
  ds_read_b64_tr_b16 a[34:35], v13 offset:17408
  ds_read_b64_tr_b16 a[36:37], v13 offset:18432
  ds_read_b64_tr_b16 a[38:39], v13 offset:19456
  ds_read_b64_tr_b16 a[40:41], v13 offset:20480
  ds_read_b64_tr_b16 a[42:43], v13 offset:21504
  ds_read_b64_tr_b16 a[44:45], v13 offset:22528
  ds_read_b64_tr_b16 a[46:47], v13 offset:23552
  ds_read_b64_tr_b16 a[48:49], v13 offset:24576
  ds_read_b64_tr_b16 a[50:51], v13 offset:25600
  ds_read_b64_tr_b16 a[52:53], v13 offset:26624
  ds_read_b64_tr_b16 a[54:55], v13 offset:27648
  ds_read_b64_tr_b16 a[56:57], v13 offset:28672
  ds_read_b64_tr_b16 a[58:59], v13 offset:29696
  ds_read_b64_tr_b16 a[60:61], v13 offset:30720
  ds_read_b64_tr_b16 a[62:63], v13 offset:31744
  s_waitcnt vmcnt(8)
  s_barrier
  ds_read_b128 a[0:3], v15 offset:8192
  ds_read_b128 a[4:7], v15 offset:9216
  ds_read_b128 a[8:11], v15 offset:10240
  ds_read_b128 a[12:15], v15 offset:11264
  ds_read_b128 a[16:19], v15 offset:12288
  ds_read_b128 a[20:23], v15 offset:13312
  ds_read_b128 a[24:27], v15 offset:14336
  ds_read_b128 a[28:31], v15 offset:15360
  s_waitcnt lgkmcnt(7)
  v_mfma_f32_32x32x16_bf16 v[192:207], a[32:35], a[0:3], v[192:207]
  s_waitcnt lgkmcnt(6)
  v_mfma_f32_32x32x16_bf16 v[192:207], a[36:39], a[4:7], v[192:207]
  s_waitcnt lgkmcnt(5)
  v_mfma_f32_32x32x16_bf16 v[192:207], a[40:43], a[8:11], v[192:207]
  s_waitcnt lgkmcnt(4)
  v_mfma_f32_32x32x16_bf16 v[192:207], a[44:47], a[12:15], v[192:207]
  s_waitcnt lgkmcnt(3)
  v_mfma_f32_32x32x16_bf16 v[192:207], a[48:51], a[16:19], v[192:207]
  s_waitcnt lgkmcnt(2)
  v_mfma_f32_32x32x16_bf16 v[192:207], a[52:55], a[20:23], v[192:207]
  s_waitcnt lgkmcnt(1)
  v_mfma_f32_32x32x16_bf16 v[192:207], a[56:59], a[24:27], v[192:207]
  s_waitcnt lgkmcnt(0)
  v_mfma_f32_32x32x16_bf16 v[192:207], a[60:63], a[28:31], v[192:207]
  ds_read_b64_tr_b16 a[32:33], v13 offset:32768
  ds_read_b64_tr_b16 a[34:35], v13 offset:33792
  ds_read_b64_tr_b16 a[36:37], v13 offset:34816
  ds_read_b64_tr_b16 a[38:39], v13 offset:35840
  ds_read_b64_tr_b16 a[40:41], v13 offset:36864
  ds_read_b64_tr_b16 a[42:43], v13 offset:37888
  ds_read_b64_tr_b16 a[44:45], v13 offset:38912
  ds_read_b64_tr_b16 a[46:47], v13 offset:39936
  ds_read_b64_tr_b16 a[48:49], v13 offset:40960
  ds_read_b64_tr_b16 a[50:51], v13 offset:41984
  ds_read_b64_tr_b16 a[52:53], v13 offset:43008
  ds_read_b64_tr_b16 a[54:55], v13 offset:44032
  ds_read_b64_tr_b16 a[56:57], v13 offset:45056
  ds_read_b64_tr_b16 a[58:59], v13 offset:46080
  ds_read_b64_tr_b16 a[60:61], v13 offset:47104
  ds_read_b64_tr_b16 a[62:63], v13 offset:48128
  s_waitcnt vmcnt(4)
  s_barrier
  ds_read_b128 a[0:3], v15 offset:16384
  ds_read_b128 a[4:7], v15 offset:17408
  ds_read_b128 a[8:11], v15 offset:18432
  ds_read_b128 a[12:15], v15 offset:19456
  ds_read_b128 a[16:19], v15 offset:20480
  ds_read_b128 a[20:23], v15 offset:21504
  ds_read_b128 a[24:27], v15 offset:22528
  ds_read_b128 a[28:31], v15 offset:23552
  s_waitcnt lgkmcnt(7)
  v_mfma_f32_32x32x16_bf16 v[192:207], a[32:35], a[0:3], v[192:207]
  s_waitcnt lgkmcnt(6)
  v_mfma_f32_32x32x16_bf16 v[192:207], a[36:39], a[4:7], v[192:207]
  s_waitcnt lgkmcnt(5)
  v_mfma_f32_32x32x16_bf16 v[192:207], a[40:43], a[8:11], v[192:207]
  s_waitcnt lgkmcnt(4)
  v_mfma_f32_32x32x16_bf16 v[192:207], a[44:47], a[12:15], v[192:207]
  s_waitcnt lgkmcnt(3)
  v_mfma_f32_32x32x16_bf16 v[192:207], a[48:51], a[16:19], v[192:207]
  s_waitcnt lgkmcnt(2)
  v_mfma_f32_32x32x16_bf16 v[192:207], a[52:55], a[20:23], v[192:207]
  s_waitcnt lgkmcnt(1)
  v_mfma_f32_32x32x16_bf16 v[192:207], a[56:59], a[24:27], v[192:207]
  s_waitcnt lgkmcnt(0)
  v_mfma_f32_32x32x16_bf16 v[192:207], a[60:63], a[28:31], v[192:207]
  ds_read_b64_tr_b16 a[32:33], v13 offset:49152
  ds_read_b64_tr_b16 a[34:35], v13 offset:50176
  ds_read_b64_tr_b16 a[36:37], v13 offset:51200
  ds_read_b64_tr_b16 a[38:39], v13 offset:52224
  ds_read_b64_tr_b16 a[40:41], v13 offset:53248
  ds_read_b64_tr_b16 a[42:43], v13 offset:54272
  ds_read_b64_tr_b16 a[44:45], v13 offset:55296
  ds_read_b64_tr_b16 a[46:47], v13 offset:56320
  ds_read_b64_tr_b16 a[48:49], v13 offset:57344
  ds_read_b64_tr_b16 a[50:51], v13 offset:58368
  ds_read_b64_tr_b16 a[52:53], v13 offset:59392
  ds_read_b64_tr_b16 a[54:55], v13 offset:60416
  ds_read_b64_tr_b16 a[56:57], v13 offset:61440
  ds_read_b64_tr_b16 a[58:59], v13 offset:62464
  ds_read_b64_tr_b16 a[60:61], v13 offset:63488
  ds_read_b64_tr_b16 a[62:63], v13 offset:64512
  s_waitcnt vmcnt(0)
  s_barrier
  ds_read_b128 a[0:3], v15 offset:24576
  ds_read_b128 a[4:7], v15 offset:25600
  ds_read_b128 a[8:11], v15 offset:26624
  ds_read_b128 a[12:15], v15 offset:27648
  ds_read_b128 a[16:19], v15 offset:28672
  ds_read_b128 a[20:23], v15 offset:29696
  ds_read_b128 a[24:27], v15 offset:30720
  ds_read_b128 a[28:31], v15 offset:31744
  s_waitcnt lgkmcnt(7)
  v_mfma_f32_32x32x16_bf16 v[192:207], a[32:35], a[0:3], v[192:207]
  s_waitcnt lgkmcnt(6)
  v_mfma_f32_32x32x16_bf16 v[192:207], a[36:39], a[4:7], v[192:207]
  s_waitcnt lgkmcnt(5)
  v_mfma_f32_32x32x16_bf16 v[192:207], a[40:43], a[8:11], v[192:207]
  s_waitcnt lgkmcnt(4)
  v_mfma_f32_32x32x16_bf16 v[192:207], a[44:47], a[12:15], v[192:207]
  s_waitcnt lgkmcnt(3)
  v_mfma_f32_32x32x16_bf16 v[192:207], a[48:51], a[16:19], v[192:207]
  s_waitcnt lgkmcnt(2)
  v_mfma_f32_32x32x16_bf16 v[192:207], a[52:55], a[20:23], v[192:207]
  s_waitcnt lgkmcnt(1)
  v_mfma_f32_32x32x16_bf16 v[192:207], a[56:59], a[24:27], v[192:207]
  s_waitcnt lgkmcnt(0)
  v_mfma_f32_32x32x16_bf16 v[192:207], a[60:63], a[28:31], v[192:207]
  s_nop 11
  v_cvt_pk_bf16_f32 v144, v192, v193
  v_cvt_pk_bf16_f32 v145, v194, v195
  v_cvt_pk_bf16_f32 v146, v196, v197
  v_cvt_pk_bf16_f32 v147, v198, v199
  v_cvt_pk_bf16_f32 v148, v200, v201
  v_cvt_pk_bf16_f32 v149, v202, v203
  v_cvt_pk_bf16_f32 v150, v204, v205
  v_cvt_pk_bf16_f32 v151, v206, v207
  v_permlane32_swap_b32 v144, v146
  v_permlane32_swap_b32 v145, v147
  v_permlane32_swap_b32 v148, v150
  v_permlane32_swap_b32 v149, v151
  buffer_store_dwordx4 v[144:147], v12, s[28:31], s95 offen offset:0
  buffer_store_dwordx4 v[148:151], v12, s[28:31], s95 offen offset:32
L_exit:
  s_endpgm
.fill 256, 4, 0xbf800000
.section .rodata,"a"
.p2align 6
.amdhsa_kernel parallel_sum__mha_block__geglu_ffn__prompt_kernel
  .amdhsa_next_free_vgpr 512
  .amdhsa_next_free_sgpr 102
  .amdhsa_accum_offset 256
  .amdhsa_group_segment_fixed_size 0
  .amdhsa_kernarg_size 80
  .amdhsa_user_sgpr_count 2
  .amdhsa_user_sgpr_kernarg_segment_ptr 1
  .amdhsa_system_sgpr_workgroup_id_x 1
  .amdhsa_float_denorm_mode_32 3
.end_amdhsa_kernel
```
